```python
import torch

def _softmax(x, axis=-1):
    return torch.softmax(x, dim=axis)
def _gelu(x):
    return torch.nn.functional.gelu(x, approximate="tanh")
def _silu(x):
    return torch.nn.functional.silu(x)
def _sigmoid(x):
    return torch.sigmoid(x)
def _layernorm(x, axis=-1, eps=1e-5):
    m = x.mean(dim=axis, keepdim=True)
    v = x.var(dim=axis, keepdim=True, unbiased=False)
    return (x - m) / torch.sqrt(v + eps)
def _scatter_add(tgt, idx, src, axis=0):
    return tgt.clone().index_add_(axis, idx, src)
def _segment_sum(src, seg, n):
    out = torch.zeros((n,) + src.shape[1:], dtype=src.dtype)
    return out.index_add_(0, seg, src)
def _pad(x, pw):
    flat = tuple(v for pair in reversed(pw) for v in pair)
    return torch.nn.functional.pad(x, flat)

kernel_name = 'interleave_layers__sliding_block__mixer_token_mlp__prompt'

def setup_inputs():

    _w = (lambda a: (lambda t: t.to(torch.bfloat16) if t.is_floating_point() else t)(torch.as_tensor(a)))
    def _A_setup():
        B, S, D = 1, 2048, 448
        return {
            "x": _w((lambda *s: torch.randn(*s, dtype=torch.bfloat16) * 0.05)(B, S, D)),
            "wqkv": _w((lambda *s: torch.randn(*s, dtype=torch.bfloat16) * 0.05)(D, 3 * D)),
            "wo": _w((lambda *s: torch.randn(*s, dtype=torch.bfloat16) * 0.05)(D, D)),
        }
    _A_in = _A_setup()

    def _B_setup():
        B, S, D, F = 1, 2048, 448, 1792
        return {
            "x": _w((lambda *s: torch.randn(*s, dtype=torch.bfloat16) * 0.05)(B, S, D)),
            "w1": _w((lambda *s: torch.randn(*s, dtype=torch.bfloat16) * 1.6)(S, F) * (S ** -0.5)),
            "b1": _w((lambda *s: torch.randn(*s, dtype=torch.bfloat16) * 12.8)(F) * 0.02),
            "w2": _w((lambda *s: torch.randn(*s, dtype=torch.bfloat16) * 0.8)(F, S) * (F ** -0.5)),
            "b2": _w((lambda *s: torch.randn(*s, dtype=torch.bfloat16) * 12.8)(S) * 0.02),
        }
    _B_in = _B_setup()

    return {
        "A_x": _A_in["x"],
        "A_wqkv": _A_in["wqkv"],
        "A_wo": _A_in["wo"],
        "B_x": _B_in["x"],
        "B_w1": _B_in["w1"],
        "B_b1": _B_in["b1"],
        "B_w2": _B_in["w2"],
        "B_b2": _B_in["b2"],
    }

def reference(A_x, A_wqkv, A_wo, B_x, B_w1, B_b1, B_w2, B_b2):
    def _A_ref(x, wqkv, wo):
        B, S, D = x.shape
        H = 16; Dh = D // H; W = 256
        qkv = (lambda x, *d: x.permute(*d))((x @ wqkv).reshape(B, S, 3, H, Dh), 2, 0, 3, 1, 4)
        q, k, v = qkv[0], qkv[1], qkv[2]
        scores = torch.einsum("bhqd,bhkd->bhqk", q, k) * (Dh ** -0.5)
        idx = torch.arange(S)
        mask = (idx[:, None] - idx[None, :] >= 0) & (idx[:, None] - idx[None, :] < W)
        scores = torch.where(mask[None, None], scores, -1e9)
        p = _softmax(scores, axis=-1)
        o = torch.einsum("bhqk,bhkd->bhqd", p, v)
        return (lambda x, *d: x.permute(*d))(o, 0, 2, 1, 3).reshape(B, S, D) @ wo

    def _B_ref(x, w1, b1, w2, b2):
        B, S, D = x.shape
        h = _layernorm(x, axis=-1)
        u = torch.einsum("bsd,sf->bdf", h, w1) + b1
        u = _gelu(u)
        y = torch.einsum("bdf,fs->bds", u, w2) + b2
        return (lambda x, *d: x.permute(*d))(y, 0, 2, 1)

    x = A_x
    x = x + _A_ref(_layernorm(x, axis=-1), A_wqkv, A_wo)
    x = x + _B_ref(_layernorm(x, axis=-1), B_w1, B_b1, B_w2, B_b2)
    x = x + _A_ref(_layernorm(x, axis=-1), A_wqkv, A_wo)
    x = x + _B_ref(_layernorm(x, axis=-1), B_w1, B_b1, B_w2, B_b2)
    return x
```

```asm
; @launch grid=(256,1,1) block=(512,1,1) lds=163840
.amdgcn_target "amdgcn-amd-amdhsa--gfx950"
.text
.globl interleave_layers__sliding_block__mixer_token_mlp__prompt_kernel
.p2align 8
.type interleave_layers__sliding_block__mixer_token_mlp__prompt_kernel,@function
interleave_layers__sliding_block__mixer_token_mlp__prompt_kernel:
  s_cmp_ge_u32 s2, 256
  s_cbranch_scc1 L_end

  s_load_dwordx16 s[64:79], s[0:1], 0
  s_load_dwordx4 s[80:83], s[0:1], 64
  s_load_dwordx2 s[84:85], s[0:1], 80
  s_getpc_b64 s[88:89]
  s_and_b32 s4, s2, 7
  s_lshr_b32 s5, s2, 3
  v_lshrrev_b32 v3, 6, v0
  v_and_b32 v1, 63, v0
  v_readfirstlane_b32 s6, v3
  v_lshlrev_b32 v2, 4, v1
  s_lshl_b32 s24, s5, 3
  s_add_u32 s24, s24, s6
  s_lshl_b32 s24, s24, 7
  s_cmp_ge_u32 s24, L_end-interleave_layers__sliding_block__mixer_token_mlp__prompt_kernel-128
  s_cbranch_scc1 L_nopf
  v_add_u32 v4, s24, v2
  s_mov_b64 exec, 0xff
  global_load_dwordx4 v[124:127], v4, s[88:89]
  s_mov_b64 exec, -1
L_nopf:
  s_mul_i32 s24, s5, 37
  s_lshr_b32 s52, s24, 8
  s_mul_i32 s24, s52, 7
  s_sub_u32 s51, s5, s24
  s_lshl_b32 s24, s4, 2
  s_add_u32 s50, s24, s52
  s_mov_b32 s7, 0
  s_mov_b32 s49, 0
  s_mov_b32 s48, 33554432
  s_mov_b32 s54, 0
  s_and_b32 s61, s5, 15
  v_mov_b32 v0, 0
  s_waitcnt lgkmcnt(0)
  s_mov_b32 s8, s84
  s_mov_b32 s9, s85
  s_mov_b32 s10, 268435456
  s_mov_b32 s11, 0x20000
  s_mov_b32 s20, s82
  s_mov_b32 s21, s83
  s_mov_b32 s22, 256
  s_mov_b32 s23, 0x20000
  s_mov_b32 s12, s66
  s_mov_b32 s13, s67
  s_mov_b32 s14, 1204224
  s_mov_b32 s15, 0x20000
  v_add_u32 v3, 0, v1
  v_mul_u32_u24 v4, 171, v3
  v_lshrrev_b32 v4, 11, v4
  v_mul_u32_u24 v5, 12, v4
  v_sub_u32 v5, v3, v5
  v_lshrrev_b32 v6, 2, v5
  v_and_b32 v5, 3, v5
  v_bfe_u32 v7, v4, 3, 1
  v_lshlrev_b32 v7, 1, v7
  v_xor_b32 v5, v5, v7
  v_mul_u32_u24 v4, 2688, v4
  v_mul_u32_u24 v6, 896, v6
  v_lshlrev_b32 v5, 4, v5
  v_add3_u32 v8, v4, v5, v6
  v_add_u32 v3, 64, v1
  v_mul_u32_u24 v4, 171, v3
  v_lshrrev_b32 v4, 11, v4
  v_mul_u32_u24 v5, 12, v4
  v_sub_u32 v5, v3, v5
  v_lshrrev_b32 v6, 2, v5
  v_and_b32 v5, 3, v5
  v_bfe_u32 v7, v4, 3, 1
  v_lshlrev_b32 v7, 1, v7
  v_xor_b32 v5, v5, v7
  v_mul_u32_u24 v4, 2688, v4
  v_mul_u32_u24 v6, 896, v6
  v_lshlrev_b32 v5, 4, v5
  v_add3_u32 v9, v4, v5, v6
  v_add_u32 v3, 128, v1
  v_mul_u32_u24 v4, 171, v3
  v_lshrrev_b32 v4, 11, v4
  v_mul_u32_u24 v5, 12, v4
  v_sub_u32 v5, v3, v5
  v_lshrrev_b32 v6, 2, v5
  v_and_b32 v5, 3, v5
  v_bfe_u32 v7, v4, 3, 1
  v_lshlrev_b32 v7, 1, v7
  v_xor_b32 v5, v5, v7
  v_mul_u32_u24 v4, 2688, v4
  v_mul_u32_u24 v6, 896, v6
  v_lshlrev_b32 v5, 4, v5
  v_add3_u32 v10, v4, v5, v6
  s_mul_i32 s24, s61, 56
  s_mul_i32 s25, s6, 43008
  s_add_u32 s24, s24, s25
  s_mul_i32 s26, s6, 3072
  s_add_u32 m0, s26, 0
  s_add_u32 s27, s24, 0
  buffer_load_dwordx4 v8, s[12:15], s27 offen lds
  s_add_u32 m0, s26, 1024
  s_add_u32 s27, s24, 0
  buffer_load_dwordx4 v9, s[12:15], s27 offen lds
  s_add_u32 m0, s26, 2048
  s_add_u32 s27, s24, 0
  buffer_load_dwordx4 v10, s[12:15], s27 offen lds
  s_add_u32 m0, s26, 24576
  s_add_u32 s27, s24, 344064
  buffer_load_dwordx4 v8, s[12:15], s27 offen lds
  s_add_u32 m0, s26, 25600
  s_add_u32 s27, s24, 344064
  buffer_load_dwordx4 v9, s[12:15], s27 offen lds
  s_add_u32 m0, s26, 26624
  s_add_u32 s27, s24, 344064
  buffer_load_dwordx4 v10, s[12:15], s27 offen lds
  s_add_u32 m0, s26, 49152
  s_add_u32 s27, s24, 688128
  buffer_load_dwordx4 v8, s[12:15], s27 offen lds
  s_add_u32 m0, s26, 50176
  s_add_u32 s27, s24, 688128
  buffer_load_dwordx4 v9, s[12:15], s27 offen lds
  s_add_u32 m0, s26, 51200
  s_add_u32 s27, s24, 688128
  buffer_load_dwordx4 v10, s[12:15], s27 offen lds
  s_cmp_ge_u32 s6, 4
  s_cbranch_scc1 L_qw_1
  s_add_u32 m0, s26, 73728
  s_add_u32 s27, s24, 1032192
  buffer_load_dwordx4 v8, s[12:15], s27 offen lds
  s_add_u32 m0, s26, 74752
  s_add_u32 s27, s24, 1032192
  buffer_load_dwordx4 v9, s[12:15], s27 offen lds
  s_add_u32 m0, s26, 75776
  s_add_u32 s27, s24, 1032192
  buffer_load_dwordx4 v10, s[12:15], s27 offen lds
L_qw_1:
  s_mov_b32 s12, s72
  s_mov_b32 s13, s73
  s_mov_b32 s14, 7340032
  s_mov_b32 s15, 0x20000
  s_mov_b32 s16, s76
  s_mov_b32 s17, s77
  s_mov_b32 s18, 7340032
  s_mov_b32 s19, 0x20000
  v_lshrrev_b32 v3, 3, v1
  v_and_b32 v4, 7, v1
  v_bfe_u32 v5, v3, 1, 1
  v_lshlrev_b32 v5, 2, v5
  v_xor_b32 v4, v4, v5
  v_mul_u32_u24 v5, 3584, v3
  v_lshl_add_u32 v8, v4, 4, v5
  v_mul_u32_u24 v5, 4096, v3
  v_lshl_add_u32 v9, v4, 4, v5
  s_lshl_b32 s30, s5, 2
  s_lshr_b32 s31, s6, 1
  s_add_u32 s30, s30, s31
  s_and_b32 s31, s6, 1
  s_lshl_b32 s31, s31, 1
  s_lshl_b32 s32, s4, 2
  s_add_u32 s31, s31, s32
  s_mul_i32 s33, s30, 57344
  s_mul_i32 s34, s31, 112
  s_add_u32 s33, s33, s34
  s_min_u32 s35, s30, 111
  s_mul_i32 s35, s35, 65536
  s_lshl_b32 s34, s31, 7
  s_add_u32 s35, s35, s34
  s_lshl_b32 s26, s6, 13
  s_add_u32 s26, s26, 86016
  s_add_u32 m0, s26, 0
  s_add_u32 s27, s33, 0
  buffer_load_dwordx4 v8, s[12:15], s27 offen lds
  s_add_u32 m0, s26, 1024
  s_add_u32 s27, s33, 28672
  buffer_load_dwordx4 v8, s[12:15], s27 offen lds
  s_add_u32 m0, s26, 2048
  s_add_u32 s27, s33, 112
  buffer_load_dwordx4 v8, s[12:15], s27 offen lds
  s_add_u32 m0, s26, 3072
  s_add_u32 s27, s33, 28784
  buffer_load_dwordx4 v8, s[12:15], s27 offen lds
  s_add_u32 m0, s26, 4096
  s_add_u32 s27, s35, 0
  buffer_load_dwordx4 v9, s[16:19], s27 offen lds
  s_add_u32 m0, s26, 5120
  s_add_u32 s27, s35, 32768
  buffer_load_dwordx4 v9, s[16:19], s27 offen lds
  s_add_u32 m0, s26, 6144
  s_add_u32 s27, s35, 128
  buffer_load_dwordx4 v9, s[16:19], s27 offen lds
  s_add_u32 m0, s26, 7168
  s_add_u32 s27, s35, 32896
  buffer_load_dwordx4 v9, s[16:19], s27 offen lds
  v_mov_b32 v4, 0
  s_cmp_ge_u32 s5, 28
  s_cbranch_scc1 L_z_2
  s_and_b32 s24, s6, 3
  s_lshl_b32 s25, s50, 2
  s_add_u32 s24, s24, s25
  s_lshl_b32 s24, s24, 4
  s_lshr_b32 s25, s6, 2
  s_add_u32 s24, s24, s25
  s_lshl_b32 s25, s51, 1
  s_add_u32 s24, s24, s25
  s_lshl_b32 s24, s24, 2
  s_add_u32 s24, s24, 32768
  v_lshlrev_b32 v5, 13, v1
  v_add_u32 v5, s24, v5
  s_mov_b64 exec, 3
  buffer_store_dword v4, v5, s[8:11], 0 offen sc1
  s_mov_b64 exec, -1
L_z_2:
  s_cmp_lg_u32 s6, 0
  s_cbranch_scc1 L_z_3
  s_lshl_b32 s25, s2, 7
  s_lshl_b32 s26, s4, 7
  s_lshl_b32 s27, s5, 2
  s_add_u32 s26, s26, s27
  s_add_u32 s26, s26, 49152
  s_mov_b64 exec, 1
  buffer_store_dword v4, off, s[8:11], s25 sc1
  buffer_store_dword v4, off, s[8:11], s26 sc1
  s_mov_b64 exec, -1
L_z_3:
  s_cmp_lg_u32 s6, 6
  s_cbranch_scc1 L_tw_4
  v_lshlrev_b32 v3, 21, v1
  s_mov_b64 exec, 0xffffffff
  buffer_load_dword v11, v3, s[8:11], 0 offen
  s_mov_b64 exec, 0xf
  s_mov_b32 s16, s72
  s_mov_b32 s17, s73
  s_mov_b32 s18, 7340032
  s_mov_b32 s19, 0x20000
  buffer_load_dword v12, v3, s[16:19], 0 offen
  s_mov_b32 s16, s76
  s_mov_b32 s17, s77
  s_mov_b32 s18, 7340032
  s_mov_b32 s19, 0x20000
  s_nop 4
  buffer_load_dword v13, v3, s[16:19], 0 offen
  s_mov_b64 exec, 1
  s_mov_b32 s16, s68
  s_mov_b32 s17, s69
  s_mov_b32 s18, 401408
  s_mov_b32 s19, 0x20000
  buffer_load_dword v14, v3, s[16:19], 0 offen
  s_mov_b32 s16, s80
  s_mov_b32 s17, s81
  s_mov_b32 s18, 1835008
  s_mov_b32 s19, 0x20000
  buffer_load_dword v15, v3, s[16:19], 0 offen
  s_mov_b64 exec, -1
  s_waitcnt vmcnt(5)
  s_branch L_tw_5
L_tw_4:
  s_waitcnt vmcnt(0)
L_tw_5:
  s_barrier
  s_cmp_lg_u32 s6, 0
  s_cbranch_scc1 L_z_6
  s_getreg_b32 s24, hwreg(HW_REG_XCC_ID)
  s_and_b32 s24, s24, 15
  s_or_b32 s24, s24, 0x80
  v_mov_b32 v4, s24
  s_mov_b64 exec, 1
  buffer_store_byte v4, off, s[20:23], s2 sc1
  s_mov_b64 exec, -1
L_z_6:
  v_lshrrev_b32 v3, 4, v1
  v_bfe_u32 v4, v1, 2, 2
  v_lshl_add_u32 v4, v3, 3, v4
  v_mul_u32_u24 v4, 192, v4
  v_and_b32 v5, 1, v1
  v_lshl_add_u32 v4, v5, 3, v4
  v_bfe_u32 v5, v1, 1, 1
  v_and_b32 v6, 1, v3
  v_lshlrev_b32 v6, 1, v6
  v_xor_b32 v5, v5, v6
  v_xor_b32 v6, 2, v5
  v_lshl_add_u32 v24, v5, 4, v4
  v_lshl_add_u32 v25, v6, 4, v4
  s_and_b32 s24, s6, 1
  s_cmp_eq_u32 s24, 0
  s_cselect_b64 vcc, -1, 0
  s_lshl_b32 s25, s24, 6
  v_cndmask_b32 v26, v25, v24, vcc
  v_add_u32 v26, 128, v26
  v_add_u32 v24, s25, v24
  v_add_u32 v25, s25, v25
  ds_read_b64_tr_b16 v[88:89], v24 offset:0
  ds_read_b64_tr_b16 v[90:91], v24 offset:768
  ds_read_b64_tr_b16 v[92:93], v25 offset:0
  ds_read_b64_tr_b16 v[94:95], v25 offset:768
  ds_read_b64_tr_b16 v[96:97], v26 offset:0
  ds_read_b64_tr_b16 v[98:99], v26 offset:768
  ds_read_b64_tr_b16 v[100:101], v24 offset:6144
  ds_read_b64_tr_b16 v[102:103], v24 offset:6912
  ds_read_b64_tr_b16 v[104:105], v25 offset:6144
  ds_read_b64_tr_b16 v[106:107], v25 offset:6912
  ds_read_b64_tr_b16 v[108:109], v26 offset:6144
  ds_read_b64_tr_b16 v[110:111], v26 offset:6912
  s_waitcnt lgkmcnt(6)
  ds_read_b64_tr_b16 v[112:113], v24 offset:12288
  ds_read_b64_tr_b16 v[114:115], v24 offset:13056
  ds_read_b64_tr_b16 v[116:117], v25 offset:12288
  ds_read_b64_tr_b16 v[118:119], v25 offset:13056
  ds_read_b64_tr_b16 v[120:121], v26 offset:12288
  ds_read_b64_tr_b16 v[122:123], v26 offset:13056
  ds_read_b64_tr_b16 v[124:125], v24 offset:18432
  ds_read_b64_tr_b16 v[126:127], v24 offset:19200
  ds_read_b64_tr_b16 v[128:129], v25 offset:18432
  ds_read_b64_tr_b16 v[130:131], v25 offset:19200
  ds_read_b64_tr_b16 v[132:133], v26 offset:18432
  ds_read_b64_tr_b16 v[134:135], v26 offset:19200
  s_waitcnt lgkmcnt(6)
  ds_read_b64_tr_b16 v[136:137], v24 offset:24576
  ds_read_b64_tr_b16 v[138:139], v24 offset:25344
  ds_read_b64_tr_b16 v[140:141], v25 offset:24576
  ds_read_b64_tr_b16 v[142:143], v25 offset:25344
  ds_read_b64_tr_b16 v[144:145], v26 offset:24576
  ds_read_b64_tr_b16 v[146:147], v26 offset:25344
  ds_read_b64_tr_b16 v[148:149], v24 offset:30720
  ds_read_b64_tr_b16 v[150:151], v24 offset:31488
  ds_read_b64_tr_b16 v[152:153], v25 offset:30720
  ds_read_b64_tr_b16 v[154:155], v25 offset:31488
  ds_read_b64_tr_b16 v[156:157], v26 offset:30720
  ds_read_b64_tr_b16 v[158:159], v26 offset:31488
  s_waitcnt lgkmcnt(6)
  ds_read_b64_tr_b16 v[160:161], v24 offset:36864
  ds_read_b64_tr_b16 v[162:163], v24 offset:37632
  ds_read_b64_tr_b16 v[164:165], v25 offset:36864
  ds_read_b64_tr_b16 v[166:167], v25 offset:37632
  ds_read_b64_tr_b16 v[168:169], v26 offset:36864
  ds_read_b64_tr_b16 v[170:171], v26 offset:37632
  ds_read_b64_tr_b16 v[172:173], v24 offset:43008
  ds_read_b64_tr_b16 v[174:175], v24 offset:43776
  ds_read_b64_tr_b16 v[176:177], v25 offset:43008
  ds_read_b64_tr_b16 v[178:179], v25 offset:43776
  ds_read_b64_tr_b16 v[180:181], v26 offset:43008
  ds_read_b64_tr_b16 v[182:183], v26 offset:43776
  s_waitcnt lgkmcnt(6)
  v_add_u32 v24, 49152, v24
  v_add_u32 v25, 49152, v25
  v_add_u32 v26, 49152, v26
  ds_read_b64_tr_b16 v[184:185], v24 offset:0
  ds_read_b64_tr_b16 v[186:187], v24 offset:768
  ds_read_b64_tr_b16 v[188:189], v25 offset:0
  ds_read_b64_tr_b16 v[190:191], v25 offset:768
  ds_read_b64_tr_b16 v[192:193], v26 offset:0
  ds_read_b64_tr_b16 v[194:195], v26 offset:768
  ds_read_b64_tr_b16 v[196:197], v24 offset:6144
  ds_read_b64_tr_b16 v[198:199], v24 offset:6912
  ds_read_b64_tr_b16 v[200:201], v25 offset:6144
  ds_read_b64_tr_b16 v[202:203], v25 offset:6912
  ds_read_b64_tr_b16 v[204:205], v26 offset:6144
  ds_read_b64_tr_b16 v[206:207], v26 offset:6912
  s_waitcnt lgkmcnt(6)
  ds_read_b64_tr_b16 v[208:209], v24 offset:12288
  ds_read_b64_tr_b16 v[210:211], v24 offset:13056
  ds_read_b64_tr_b16 v[212:213], v25 offset:12288
  ds_read_b64_tr_b16 v[214:215], v25 offset:13056
  ds_read_b64_tr_b16 v[216:217], v26 offset:12288
  ds_read_b64_tr_b16 v[218:219], v26 offset:13056
  ds_read_b64_tr_b16 v[220:221], v24 offset:18432
  ds_read_b64_tr_b16 v[222:223], v24 offset:19200
  ds_read_b64_tr_b16 v[224:225], v25 offset:18432
  ds_read_b64_tr_b16 v[226:227], v25 offset:19200
  ds_read_b64_tr_b16 v[228:229], v26 offset:18432
  ds_read_b64_tr_b16 v[230:231], v26 offset:19200
  s_waitcnt lgkmcnt(6)
  ds_read_b64_tr_b16 v[232:233], v24 offset:24576
  ds_read_b64_tr_b16 v[234:235], v24 offset:25344
  ds_read_b64_tr_b16 v[236:237], v25 offset:24576
  ds_read_b64_tr_b16 v[238:239], v25 offset:25344
  ds_read_b64_tr_b16 v[240:241], v26 offset:24576
  ds_read_b64_tr_b16 v[242:243], v26 offset:25344
  ds_read_b64_tr_b16 v[244:245], v24 offset:30720
  ds_read_b64_tr_b16 v[246:247], v24 offset:31488
  ds_read_b64_tr_b16 v[248:249], v25 offset:30720
  ds_read_b64_tr_b16 v[250:251], v25 offset:31488
  ds_read_b64_tr_b16 v[252:253], v26 offset:30720
  ds_read_b64_tr_b16 v[254:255], v26 offset:31488
  s_waitcnt lgkmcnt(6)
  s_lshl_b32 s26, s6, 13
  s_add_u32 s26, s26, 86016
  v_lshrrev_b32 v23, 4, v1
  v_bfe_u32 v24, v1, 2, 2
  v_lshrrev_b32 v25, 1, v23
  v_lshl_add_u32 v25, v25, 3, v24
  v_lshlrev_b32 v25, 7, v25
  v_and_b32 v26, 1, v1
  v_lshl_add_u32 v25, v26, 3, v25
  v_bfe_u32 v26, v1, 1, 1
  v_and_b32 v27, 1, v23
  v_lshl_add_u32 v26, v27, 1, v26
  v_lshl_add_u32 v25, v26, 4, v25
  v_add_u32 v25, s26, v25
  v_lshrrev_b32 v26, 1, v24
  v_lshl_add_u32 v23, v26, 6, v25
  v_xor_b32 v26, 1, v26
  v_lshl_add_u32 v24, v26, 6, v25
  ds_read_b64_tr_b16 v[32:33], v23 offset:0
  ds_read_b64_tr_b16 v[34:35], v23 offset:512
  ds_read_b64_tr_b16 v[36:37], v24 offset:0
  ds_read_b64_tr_b16 v[38:39], v24 offset:512
  ds_read_b64_tr_b16 v[40:41], v23 offset:2048
  ds_read_b64_tr_b16 v[42:43], v23 offset:2560
  ds_read_b64_tr_b16 v[44:45], v24 offset:2048
  ds_read_b64_tr_b16 v[46:47], v24 offset:2560
  ds_read_b64_tr_b16 v[48:49], v23 offset:4096
  ds_read_b64_tr_b16 v[50:51], v23 offset:4608
  ds_read_b64_tr_b16 v[52:53], v24 offset:4096
  ds_read_b64_tr_b16 v[54:55], v24 offset:4608
  ds_read_b64_tr_b16 v[56:57], v23 offset:6144
  ds_read_b64_tr_b16 v[58:59], v23 offset:6656
  ds_read_b64_tr_b16 v[60:61], v24 offset:6144
  ds_read_b64_tr_b16 v[62:63], v24 offset:6656
  s_waitcnt lgkmcnt(0)
  s_barrier
  s_mov_b32 s12, s64
  s_mov_b32 s13, s65
  s_mov_b32 s14, 1835008
  s_mov_b32 s15, 0x20000
  v_lshrrev_b32 v3, 2, v1
  v_lshrrev_b32 v4, 2, v3
  v_lshlrev_b32 v6, 1, v4
  v_mov_b32 v5, 0x78
  v_lshrrev_b32 v5, v6, v5
  v_and_b32 v5, 3, v5
  v_and_b32 v6, 3, v1
  v_xor_b32 v5, v5, v6
  v_mul_u32_u24 v3, 896, v3
  v_lshl_add_u32 v27, v5, 4, v3
  s_mov_b32 s38, 64
  s_lshl_b32 s24, s4, 4
  s_lshr_b32 s25, s5, 4
  s_lshl_b32 s25, s25, 3
  s_add_u32 s24, s24, s25
  s_add_u32 s24, s24, s6
  s_mul_i32 s39, s24, 14336
  s_mul_i32 s26, s6, 7168
  s_mul_i32 s27, s38, 0
  s_add_u32 s27, s27, s39
  s_add_u32 m0, s26, 86016
  s_nop 0
  buffer_load_dwordx4 v27, s[12:15], s27 offen sc1 lds
  s_add_u32 s27, s27, s38
  s_add_u32 m0, s26, 87040
  s_nop 0
  buffer_load_dwordx4 v27, s[12:15], s27 offen sc1 lds
  s_add_u32 s27, s27, s38
  s_add_u32 m0, s26, 88064
  s_nop 0
  buffer_load_dwordx4 v27, s[12:15], s27 offen sc1 lds
  s_add_u32 s27, s27, s38
  s_add_u32 m0, s26, 89088
  s_nop 0
  buffer_load_dwordx4 v27, s[12:15], s27 offen sc1 lds
  s_add_u32 s27, s27, s38
  s_add_u32 m0, s26, 90112
  s_nop 0
  buffer_load_dwordx4 v27, s[12:15], s27 offen sc1 lds
  s_add_u32 s27, s27, s38
  s_add_u32 m0, s26, 91136
  s_nop 0
  buffer_load_dwordx4 v27, s[12:15], s27 offen sc1 lds
  s_add_u32 s27, s27, s38
  s_add_u32 m0, s26, 92160
  s_nop 0
  buffer_load_dwordx4 v27, s[12:15], s27 offen sc1 lds
  s_add_u32 s27, s27, s38
  s_mul_i32 s26, s6, 7168
  s_mul_i32 s27, s38, 7
  s_add_u32 s27, s27, s39
  s_add_u32 m0, s26, 0
  s_nop 0
  buffer_load_dwordx4 v27, s[12:15], s27 offen sc1 lds
  s_add_u32 s27, s27, s38
  s_add_u32 m0, s26, 1024
  s_nop 0
  buffer_load_dwordx4 v27, s[12:15], s27 offen sc1 lds
  s_add_u32 s27, s27, s38
  s_add_u32 m0, s26, 2048
  s_nop 0
  buffer_load_dwordx4 v27, s[12:15], s27 offen sc1 lds
  s_add_u32 s27, s27, s38
  s_add_u32 m0, s26, 3072
  s_nop 0
  buffer_load_dwordx4 v27, s[12:15], s27 offen sc1 lds
  s_add_u32 s27, s27, s38
  s_add_u32 m0, s26, 4096
  s_nop 0
  buffer_load_dwordx4 v27, s[12:15], s27 offen sc1 lds
  s_add_u32 s27, s27, s38
  s_add_u32 m0, s26, 5120
  s_nop 0
  buffer_load_dwordx4 v27, s[12:15], s27 offen sc1 lds
  s_add_u32 s27, s27, s38
  s_add_u32 m0, s26, 6144
  s_nop 0
  buffer_load_dwordx4 v27, s[12:15], s27 offen sc1 lds
  s_add_u32 s27, s27, s38
  s_lshl_b32 s30, s5, 2
  s_lshr_b32 s31, s6, 1
  s_add_u32 s30, s30, s31
  s_and_b32 s31, s6, 1
  s_lshl_b32 s31, s31, 1
  s_lshl_b32 s32, s4, 2
  s_add_u32 s31, s31, s32
  s_lshl_b32 s33, s31, 7
  s_add_u32 s33, s33, s30
  s_lshl_b32 s33, s33, 11
  s_add_u32 s33, s33, 4194304
  s_add_u32 s34, s33, 262144
  s_mul_i32 s35, s31, 112
  s_add_u32 s35, s35, s30
  s_lshl_b32 s35, s35, 11
  s_add_u32 s35, s35, 12582912
  s_add_u32 s36, s35, 229376
  s_waitcnt lgkmcnt(0)
  buffer_store_dwordx4 v[32:35], v2, s[8:11], s33 offen offset:0
  buffer_store_dwordx4 v[36:39], v2, s[8:11], s33 offen offset:1024
  buffer_store_dwordx4 v[40:43], v2, s[8:11], s34 offen offset:0
  buffer_store_dwordx4 v[44:47], v2, s[8:11], s34 offen offset:1024
  s_cmp_ge_u32 s30, 112
  s_cbranch_scc1 L_t12_7
  buffer_store_dwordx4 v[48:51], v2, s[8:11], s35 offen offset:0
  buffer_store_dwordx4 v[52:55], v2, s[8:11], s35 offen offset:1024
  buffer_store_dwordx4 v[56:59], v2, s[8:11], s36 offen offset:0
  buffer_store_dwordx4 v[60:63], v2, s[8:11], s36 offen offset:1024
L_t12_7:
  v_and_b32 v3, 15, v1
  v_cmp_eq_u32 vcc, 12, v3
  v_mov_b32 v4, 0x3f803f80
  s_nop 0
  v_cndmask_b32 v92, v92, v4, vcc
  v_cndmask_b32 v93, v93, v4, vcc
  v_cndmask_b32 v94, v94, v4, vcc
  v_cndmask_b32 v95, v95, v4, vcc
  v_cndmask_b32 v104, v104, v4, vcc
  v_cndmask_b32 v105, v105, v4, vcc
  v_cndmask_b32 v106, v106, v4, vcc
  v_cndmask_b32 v107, v107, v4, vcc
  v_cndmask_b32 v116, v116, v4, vcc
  v_cndmask_b32 v117, v117, v4, vcc
  v_cndmask_b32 v118, v118, v4, vcc
  v_cndmask_b32 v119, v119, v4, vcc
  v_cndmask_b32 v128, v128, v4, vcc
  v_cndmask_b32 v129, v129, v4, vcc
  v_cndmask_b32 v130, v130, v4, vcc
  v_cndmask_b32 v131, v131, v4, vcc
  v_cndmask_b32 v140, v140, v4, vcc
  v_cndmask_b32 v141, v141, v4, vcc
  v_cndmask_b32 v142, v142, v4, vcc
  v_cndmask_b32 v143, v143, v4, vcc
  v_cndmask_b32 v152, v152, v4, vcc
  v_cndmask_b32 v153, v153, v4, vcc
  v_cndmask_b32 v154, v154, v4, vcc
  v_cndmask_b32 v155, v155, v4, vcc
  v_cndmask_b32 v164, v164, v4, vcc
  v_cndmask_b32 v165, v165, v4, vcc
  v_cndmask_b32 v166, v166, v4, vcc
  v_cndmask_b32 v167, v167, v4, vcc
  v_cndmask_b32 v176, v176, v4, vcc
  v_cndmask_b32 v177, v177, v4, vcc
  v_cndmask_b32 v178, v178, v4, vcc
  v_cndmask_b32 v179, v179, v4, vcc
  v_cndmask_b32 v188, v188, v4, vcc
  v_cndmask_b32 v189, v189, v4, vcc
  v_cndmask_b32 v190, v190, v4, vcc
  v_cndmask_b32 v191, v191, v4, vcc
  v_cndmask_b32 v200, v200, v4, vcc
  v_cndmask_b32 v201, v201, v4, vcc
  v_cndmask_b32 v202, v202, v4, vcc
  v_cndmask_b32 v203, v203, v4, vcc
  v_cndmask_b32 v212, v212, v4, vcc
  v_cndmask_b32 v213, v213, v4, vcc
  v_cndmask_b32 v214, v214, v4, vcc
  v_cndmask_b32 v215, v215, v4, vcc
  v_cndmask_b32 v224, v224, v4, vcc
  v_cndmask_b32 v225, v225, v4, vcc
  v_cndmask_b32 v226, v226, v4, vcc
  v_cndmask_b32 v227, v227, v4, vcc
  v_cndmask_b32 v236, v236, v4, vcc
  v_cndmask_b32 v237, v237, v4, vcc
  v_cndmask_b32 v238, v238, v4, vcc
  v_cndmask_b32 v239, v239, v4, vcc
  v_cndmask_b32 v248, v248, v4, vcc
  v_cndmask_b32 v249, v249, v4, vcc
  v_cndmask_b32 v250, v250, v4, vcc
  v_cndmask_b32 v251, v251, v4, vcc
  s_nop 4
  v_mov_b32 v84, 0x3f803f80
  v_mov_b32 v85, 0x3f803f80
  v_mov_b32 v86, 0x3f803f80
  v_mov_b32 v87, 0x3f803f80
  s_nop 1
  v_mfma_f32_16x16x32_bf16 v[52:55], v[88:91], v[84:87], 0
  v_mfma_f32_16x16x32_bf16 v[56:59], v[92:95], v[84:87], 0
  v_mfma_f32_16x16x32_bf16 v[60:63], v[84:87], v[96:99], 0
  v_mfma_f32_16x16x32_bf16 v[52:55], v[100:103], v[84:87], v[52:55]
  v_mfma_f32_16x16x32_bf16 v[56:59], v[104:107], v[84:87], v[56:59]
  v_mfma_f32_16x16x32_bf16 v[60:63], v[84:87], v[108:111], v[60:63]
  v_mfma_f32_16x16x32_bf16 v[52:55], v[112:115], v[84:87], v[52:55]
  v_mfma_f32_16x16x32_bf16 v[56:59], v[116:119], v[84:87], v[56:59]
  v_mfma_f32_16x16x32_bf16 v[60:63], v[84:87], v[120:123], v[60:63]
  v_mfma_f32_16x16x32_bf16 v[52:55], v[124:127], v[84:87], v[52:55]
  v_mfma_f32_16x16x32_bf16 v[56:59], v[128:131], v[84:87], v[56:59]
  v_mfma_f32_16x16x32_bf16 v[60:63], v[84:87], v[132:135], v[60:63]
  v_mfma_f32_16x16x32_bf16 v[52:55], v[136:139], v[84:87], v[52:55]
  v_mfma_f32_16x16x32_bf16 v[56:59], v[140:143], v[84:87], v[56:59]
  v_mfma_f32_16x16x32_bf16 v[60:63], v[84:87], v[144:147], v[60:63]
  v_mfma_f32_16x16x32_bf16 v[52:55], v[148:151], v[84:87], v[52:55]
  v_mfma_f32_16x16x32_bf16 v[56:59], v[152:155], v[84:87], v[56:59]
  v_mfma_f32_16x16x32_bf16 v[60:63], v[84:87], v[156:159], v[60:63]
  v_mfma_f32_16x16x32_bf16 v[52:55], v[160:163], v[84:87], v[52:55]
  v_mfma_f32_16x16x32_bf16 v[56:59], v[164:167], v[84:87], v[56:59]
  v_mfma_f32_16x16x32_bf16 v[60:63], v[84:87], v[168:171], v[60:63]
  v_mfma_f32_16x16x32_bf16 v[52:55], v[172:175], v[84:87], v[52:55]
  v_mfma_f32_16x16x32_bf16 v[56:59], v[176:179], v[84:87], v[56:59]
  v_mfma_f32_16x16x32_bf16 v[60:63], v[84:87], v[180:183], v[60:63]
  v_mfma_f32_16x16x32_bf16 v[52:55], v[184:187], v[84:87], v[52:55]
  v_mfma_f32_16x16x32_bf16 v[56:59], v[188:191], v[84:87], v[56:59]
  v_mfma_f32_16x16x32_bf16 v[60:63], v[84:87], v[192:195], v[60:63]
  v_mfma_f32_16x16x32_bf16 v[52:55], v[196:199], v[84:87], v[52:55]
  v_mfma_f32_16x16x32_bf16 v[56:59], v[200:203], v[84:87], v[56:59]
  v_mfma_f32_16x16x32_bf16 v[60:63], v[84:87], v[204:207], v[60:63]
  v_mfma_f32_16x16x32_bf16 v[52:55], v[208:211], v[84:87], v[52:55]
  v_mfma_f32_16x16x32_bf16 v[56:59], v[212:215], v[84:87], v[56:59]
  v_mfma_f32_16x16x32_bf16 v[60:63], v[84:87], v[216:219], v[60:63]
  v_mfma_f32_16x16x32_bf16 v[52:55], v[220:223], v[84:87], v[52:55]
  v_mfma_f32_16x16x32_bf16 v[56:59], v[224:227], v[84:87], v[56:59]
  v_mfma_f32_16x16x32_bf16 v[60:63], v[84:87], v[228:231], v[60:63]
  v_mfma_f32_16x16x32_bf16 v[52:55], v[232:235], v[84:87], v[52:55]
  v_mfma_f32_16x16x32_bf16 v[56:59], v[236:239], v[84:87], v[56:59]
  v_mfma_f32_16x16x32_bf16 v[60:63], v[84:87], v[240:243], v[60:63]
  v_mfma_f32_16x16x32_bf16 v[52:55], v[244:247], v[84:87], v[52:55]
  v_mfma_f32_16x16x32_bf16 v[56:59], v[248:251], v[84:87], v[56:59]
  v_mfma_f32_16x16x32_bf16 v[60:63], v[84:87], v[252:255], v[60:63]
  s_branch L_qkv_main
L_layer:
  s_add_u32 s12, s84, 47185920
  s_addc_u32 s13, s85, 0
  s_mov_b32 s14, 1835008
  s_mov_b32 s15, 0x20000
  v_mov_b32 v27, v2
  s_mov_b32 s38, 1024
  s_lshl_b32 s24, s4, 4
  s_lshr_b32 s25, s5, 4
  s_lshl_b32 s25, s25, 3
  s_add_u32 s24, s24, s25
  s_add_u32 s24, s24, s6
  s_mul_i32 s39, s24, 14336
  s_and_b32 s24, s5, 15
  s_mul_i32 s24, s24, 92160
  s_add_u32 s24, s24, 1048576
  s_and_b32 s25, s6, 1
  s_mul_i32 s27, s25, 46080
  s_add_u32 s24, s24, s27
  s_mul_i32 s26, s25, 43008
  s_add_u32 s28, s24, 43008
  buffer_load_dwordx4 v[52:55], v2, s[8:11], s28 offen sc1
  buffer_load_dwordx4 v[56:59], v2, s[8:11], s28 offen offset:1024 sc1
  buffer_load_dwordx4 v[60:63], v2, s[8:11], s28 offen offset:2048 sc1
  s_lshr_b32 s25, s6, 1
  s_lshl_b32 s25, s25, 10
  s_add_u32 s24, s24, s25
  s_add_u32 s26, s26, s25
  s_add_u32 m0, s26, 0
  s_add_u32 s27, s24, 0
  buffer_load_dwordx4 v2, s[8:11], s27 offen sc1 lds
  s_add_u32 m0, s26, 4096
  s_add_u32 s27, s24, 4096
  buffer_load_dwordx4 v2, s[8:11], s27 offen sc1 lds
  s_add_u32 m0, s26, 8192
  s_add_u32 s27, s24, 8192
  buffer_load_dwordx4 v2, s[8:11], s27 offen sc1 lds
  s_add_u32 m0, s26, 12288
  s_add_u32 s27, s24, 12288
  buffer_load_dwordx4 v2, s[8:11], s27 offen sc1 lds
  s_add_u32 m0, s26, 16384
  s_add_u32 s27, s24, 16384
  buffer_load_dwordx4 v2, s[8:11], s27 offen sc1 lds
  s_add_u32 m0, s26, 20480
  s_add_u32 s27, s24, 20480
  buffer_load_dwordx4 v2, s[8:11], s27 offen sc1 lds
  s_add_u32 m0, s26, 24576
  s_add_u32 s27, s24, 24576
  buffer_load_dwordx4 v2, s[8:11], s27 offen sc1 lds
  s_add_u32 m0, s26, 28672
  s_add_u32 s27, s24, 28672
  buffer_load_dwordx4 v2, s[8:11], s27 offen sc1 lds
  s_add_u32 m0, s26, 32768
  s_add_u32 s27, s24, 32768
  buffer_load_dwordx4 v2, s[8:11], s27 offen sc1 lds
  s_add_u32 m0, s26, 36864
  s_add_u32 s27, s24, 36864
  buffer_load_dwordx4 v2, s[8:11], s27 offen sc1 lds
  s_cmp_ge_u32 s6, 4
  s_cbranch_scc1 L_qw1_8
  s_add_u32 m0, s26, 40960
  s_add_u32 s27, s24, 40960
  buffer_load_dwordx4 v2, s[8:11], s27 offen sc1 lds
L_qw1_8:
  s_cmp_lg_u32 s6, 0
  s_cbranch_scc1 L_wp_9
  v_min_u32 v3, 13, v1
  s_lshr_b32 s24, s5, 4
  s_mul_i32 s24, s24, 14
  v_add_u32 v3, s24, v3
  v_lshlrev_b32 v3, 2, v3
  s_lshl_b32 s24, s4, 7
  s_add_u32 s24, s24, 49152
  v_add_u32 v3, s24, v3
  s_mov_b32 s53, 0x40000
L_poll_10:
  buffer_load_dword v4, v3, s[8:11], 0 offen sc1
  s_waitcnt vmcnt(0)
  v_cmp_gt_u32 vcc, s49, v4
  s_nop 1
  s_cbranch_vccz L_polld_11
  s_sub_u32 s53, s53, 1
  s_cmp_lg_u32 s53, 0
  s_cbranch_scc1 L_poll_10
L_polld_11:
L_wp_9:
  s_barrier
  s_mul_i32 s26, s6, 7168
  s_mul_i32 s27, s38, 0
  s_add_u32 s27, s27, s39
  s_add_u32 m0, s26, 86016
  s_nop 0
  buffer_load_dwordx4 v27, s[12:15], s27 offen sc1 lds
  s_add_u32 s27, s27, s38
  s_add_u32 m0, s26, 87040
  s_nop 0
  buffer_load_dwordx4 v27, s[12:15], s27 offen sc1 lds
  s_add_u32 s27, s27, s38
  s_add_u32 m0, s26, 88064
  s_nop 0
  buffer_load_dwordx4 v27, s[12:15], s27 offen sc1 lds
  s_add_u32 s27, s27, s38
  s_add_u32 m0, s26, 89088
  s_nop 0
  buffer_load_dwordx4 v27, s[12:15], s27 offen sc1 lds
  s_add_u32 s27, s27, s38
  s_add_u32 m0, s26, 90112
  s_nop 0
  buffer_load_dwordx4 v27, s[12:15], s27 offen sc1 lds
  s_add_u32 s27, s27, s38
  s_add_u32 m0, s26, 91136
  s_nop 0
  buffer_load_dwordx4 v27, s[12:15], s27 offen sc1 lds
  s_add_u32 s27, s27, s38
  s_add_u32 m0, s26, 92160
  s_nop 0
  buffer_load_dwordx4 v27, s[12:15], s27 offen sc1 lds
  s_add_u32 s27, s27, s38
  s_waitcnt vmcnt(7)
  s_barrier
  s_and_b32 s24, s6, 1
  s_mul_i32 s24, s24, 43008
  v_add_u32 v24, s24, v2
  ds_read_b128 v[88:91], v24 offset:0
  ds_read_b128 v[92:95], v24 offset:1024
  ds_read_b128 v[96:99], v24 offset:2048
  ds_read_b128 v[100:103], v24 offset:3072
  ds_read_b128 v[104:107], v24 offset:4096
  ds_read_b128 v[108:111], v24 offset:5120
  ds_read_b128 v[112:115], v24 offset:6144
  ds_read_b128 v[116:119], v24 offset:7168
  s_waitcnt lgkmcnt(6)
  ds_read_b128 v[120:123], v24 offset:8192
  ds_read_b128 v[124:127], v24 offset:9216
  ds_read_b128 v[128:131], v24 offset:10240
  ds_read_b128 v[132:135], v24 offset:11264
  ds_read_b128 v[136:139], v24 offset:12288
  ds_read_b128 v[140:143], v24 offset:13312
  ds_read_b128 v[144:147], v24 offset:14336
  ds_read_b128 v[148:151], v24 offset:15360
  s_waitcnt lgkmcnt(6)
  ds_read_b128 v[152:155], v24 offset:16384
  ds_read_b128 v[156:159], v24 offset:17408
  ds_read_b128 v[160:163], v24 offset:18432
  ds_read_b128 v[164:167], v24 offset:19456
  ds_read_b128 v[168:171], v24 offset:20480
  ds_read_b128 v[172:175], v24 offset:21504
  ds_read_b128 v[176:179], v24 offset:22528
  ds_read_b128 v[180:183], v24 offset:23552
  s_waitcnt lgkmcnt(6)
  ds_read_b128 v[184:187], v24 offset:24576
  ds_read_b128 v[188:191], v24 offset:25600
  ds_read_b128 v[192:195], v24 offset:26624
  ds_read_b128 v[196:199], v24 offset:27648
  ds_read_b128 v[200:203], v24 offset:28672
  ds_read_b128 v[204:207], v24 offset:29696
  ds_read_b128 v[208:211], v24 offset:30720
  ds_read_b128 v[212:215], v24 offset:31744
  s_waitcnt lgkmcnt(6)
  ds_read_b128 v[216:219], v24 offset:32768
  ds_read_b128 v[220:223], v24 offset:33792
  ds_read_b128 v[224:227], v24 offset:34816
  ds_read_b128 v[228:231], v24 offset:35840
  ds_read_b128 v[232:235], v24 offset:36864
  ds_read_b128 v[236:239], v24 offset:37888
  ds_read_b128 v[240:243], v24 offset:38912
  ds_read_b128 v[244:247], v24 offset:39936
  s_waitcnt lgkmcnt(6)
  ds_read_b128 v[248:251], v24 offset:40960
  ds_read_b128 v[252:255], v24 offset:41984
  s_waitcnt lgkmcnt(0)
  s_barrier
  s_mul_i32 s26, s6, 7168
  s_mul_i32 s27, s38, 7
  s_add_u32 s27, s27, s39
  s_add_u32 m0, s26, 0
  s_nop 0
  buffer_load_dwordx4 v27, s[12:15], s27 offen sc1 lds
  s_add_u32 s27, s27, s38
  s_add_u32 m0, s26, 1024
  s_nop 0
  buffer_load_dwordx4 v27, s[12:15], s27 offen sc1 lds
  s_add_u32 s27, s27, s38
  s_add_u32 m0, s26, 2048
  s_nop 0
  buffer_load_dwordx4 v27, s[12:15], s27 offen sc1 lds
  s_add_u32 s27, s27, s38
  s_add_u32 m0, s26, 3072
  s_nop 0
  buffer_load_dwordx4 v27, s[12:15], s27 offen sc1 lds
  s_add_u32 s27, s27, s38
  s_add_u32 m0, s26, 4096
  s_nop 0
  buffer_load_dwordx4 v27, s[12:15], s27 offen sc1 lds
  s_add_u32 s27, s27, s38
  s_add_u32 m0, s26, 5120
  s_nop 0
  buffer_load_dwordx4 v27, s[12:15], s27 offen sc1 lds
  s_add_u32 s27, s27, s38
  s_add_u32 m0, s26, 6144
  s_nop 0
  buffer_load_dwordx4 v27, s[12:15], s27 offen sc1 lds
  s_add_u32 s27, s27, s38
L_qkv_main:
  v_and_b32 v3, 15, v1
  v_lshrrev_b32 v4, 2, v3
  v_lshlrev_b32 v6, 1, v4
  v_mov_b32 v5, 0x78
  v_lshrrev_b32 v5, v6, v5
  v_and_b32 v5, 3, v5
  v_lshrrev_b32 v6, 4, v1
  v_xor_b32 v5, v5, v6
  v_lshl_add_u32 v5, v3, 2, v5
  v_lshlrev_b32 v5, 4, v5
  s_lshr_b32 s24, s6, 1
  s_mul_i32 s24, s24, 14336
  v_add_u32 v29, s24, v5
  v_add_u32 v28, 86016, v29
  s_and_b32 s31, s6, 1
  s_mul_i32 s25, s31, 7168
  v_add_u32 v30, s25, v28
  v_add_u32 v31, s25, v29
  s_waitcnt vmcnt(11)
  s_barrier
  ds_read_b128 v[36:39], v28 offset:0
  ds_read_b128 v[40:43], v28 offset:7168
  ds_read_b128 v[16:19], v30 offset:0
  ds_read_b128 v[44:47], v28 offset:1024
  ds_read_b128 v[48:51], v28 offset:8192
  ds_read_b128 v[20:23], v30 offset:1024
  s_waitcnt lgkmcnt(3)
  v_mfma_f32_16x16x32_bf16 v[64:67], v[88:91], v[36:39], 0
  v_mfma_f32_16x16x32_bf16 v[68:71], v[92:95], v[36:39], 0
  v_mfma_f32_16x16x32_bf16 v[72:75], v[36:39], v[96:99], 0
  v_mfma_f32_16x16x32_bf16 v[76:79], v[88:91], v[40:43], 0
  v_mfma_f32_16x16x32_bf16 v[80:83], v[92:95], v[40:43], 0
  v_mfma_f32_16x16x32_bf16 v[84:87], v[40:43], v[96:99], 0
  v_mfma_f32_16x16x32_bf16 v[32:35], v[16:19], v[16:19], 0
  ds_read_b128 v[36:39], v28 offset:2048
  ds_read_b128 v[40:43], v28 offset:9216
  ds_read_b128 v[16:19], v30 offset:2048
  s_waitcnt lgkmcnt(3)
  v_mfma_f32_16x16x32_bf16 v[64:67], v[100:103], v[44:47], v[64:67]
  v_mfma_f32_16x16x32_bf16 v[68:71], v[104:107], v[44:47], v[68:71]
  v_mfma_f32_16x16x32_bf16 v[72:75], v[44:47], v[108:111], v[72:75]
  v_mfma_f32_16x16x32_bf16 v[76:79], v[100:103], v[48:51], v[76:79]
  v_mfma_f32_16x16x32_bf16 v[80:83], v[104:107], v[48:51], v[80:83]
  v_mfma_f32_16x16x32_bf16 v[84:87], v[48:51], v[108:111], v[84:87]
  v_mfma_f32_16x16x32_bf16 v[32:35], v[20:23], v[20:23], v[32:35]
  s_waitcnt lgkmcnt(0)
  v_mfma_f32_16x16x32_bf16 v[64:67], v[112:115], v[36:39], v[64:67]
  v_mfma_f32_16x16x32_bf16 v[68:71], v[116:119], v[36:39], v[68:71]
  v_mfma_f32_16x16x32_bf16 v[72:75], v[36:39], v[120:123], v[72:75]
  v_mfma_f32_16x16x32_bf16 v[76:79], v[112:115], v[40:43], v[76:79]
  v_mfma_f32_16x16x32_bf16 v[80:83], v[116:119], v[40:43], v[80:83]
  v_mfma_f32_16x16x32_bf16 v[84:87], v[40:43], v[120:123], v[84:87]
  v_mfma_f32_16x16x32_bf16 v[32:35], v[16:19], v[16:19], v[32:35]
  s_waitcnt vmcnt(7)
  s_barrier
  ds_read_b128 v[44:47], v28 offset:3072
  ds_read_b128 v[48:51], v28 offset:10240
  ds_read_b128 v[20:23], v30 offset:3072
  ds_read_b128 v[36:39], v28 offset:4096
  ds_read_b128 v[40:43], v28 offset:11264
  ds_read_b128 v[16:19], v30 offset:4096
  s_waitcnt lgkmcnt(3)
  v_mfma_f32_16x16x32_bf16 v[64:67], v[124:127], v[44:47], v[64:67]
  v_mfma_f32_16x16x32_bf16 v[68:71], v[128:131], v[44:47], v[68:71]
  v_mfma_f32_16x16x32_bf16 v[72:75], v[44:47], v[132:135], v[72:75]
  v_mfma_f32_16x16x32_bf16 v[76:79], v[124:127], v[48:51], v[76:79]
  v_mfma_f32_16x16x32_bf16 v[80:83], v[128:131], v[48:51], v[80:83]
  v_mfma_f32_16x16x32_bf16 v[84:87], v[48:51], v[132:135], v[84:87]
  v_mfma_f32_16x16x32_bf16 v[32:35], v[20:23], v[20:23], v[32:35]
  ds_read_b128 v[44:47], v28 offset:5120
  ds_read_b128 v[48:51], v28 offset:12288
  ds_read_b128 v[20:23], v30 offset:5120
  s_waitcnt lgkmcnt(3)
  v_mfma_f32_16x16x32_bf16 v[64:67], v[136:139], v[36:39], v[64:67]
  v_mfma_f32_16x16x32_bf16 v[68:71], v[140:143], v[36:39], v[68:71]
  v_mfma_f32_16x16x32_bf16 v[72:75], v[36:39], v[144:147], v[72:75]
  v_mfma_f32_16x16x32_bf16 v[76:79], v[136:139], v[40:43], v[76:79]
  v_mfma_f32_16x16x32_bf16 v[80:83], v[140:143], v[40:43], v[80:83]
  v_mfma_f32_16x16x32_bf16 v[84:87], v[40:43], v[144:147], v[84:87]
  v_mfma_f32_16x16x32_bf16 v[32:35], v[16:19], v[16:19], v[32:35]
  ds_read_b128 v[36:39], v28 offset:6144
  ds_read_b128 v[40:43], v28 offset:13312
  ds_read_b128 v[16:19], v30 offset:6144
  s_waitcnt lgkmcnt(3)
  v_mfma_f32_16x16x32_bf16 v[64:67], v[148:151], v[44:47], v[64:67]
  v_mfma_f32_16x16x32_bf16 v[68:71], v[152:155], v[44:47], v[68:71]
  v_mfma_f32_16x16x32_bf16 v[72:75], v[44:47], v[156:159], v[72:75]
  v_mfma_f32_16x16x32_bf16 v[76:79], v[148:151], v[48:51], v[76:79]
  v_mfma_f32_16x16x32_bf16 v[80:83], v[152:155], v[48:51], v[80:83]
  v_mfma_f32_16x16x32_bf16 v[84:87], v[48:51], v[156:159], v[84:87]
  v_mfma_f32_16x16x32_bf16 v[32:35], v[20:23], v[20:23], v[32:35]
  s_waitcnt lgkmcnt(0)
  v_mfma_f32_16x16x32_bf16 v[64:67], v[160:163], v[36:39], v[64:67]
  v_mfma_f32_16x16x32_bf16 v[68:71], v[164:167], v[36:39], v[68:71]
  v_mfma_f32_16x16x32_bf16 v[72:75], v[36:39], v[168:171], v[72:75]
  v_mfma_f32_16x16x32_bf16 v[76:79], v[160:163], v[40:43], v[76:79]
  v_mfma_f32_16x16x32_bf16 v[80:83], v[164:167], v[40:43], v[80:83]
  v_mfma_f32_16x16x32_bf16 v[84:87], v[40:43], v[168:171], v[84:87]
  v_mfma_f32_16x16x32_bf16 v[32:35], v[16:19], v[16:19], v[32:35]
  s_waitcnt vmcnt(3)
  s_barrier
  ds_read_b128 v[44:47], v29 offset:0
  ds_read_b128 v[48:51], v29 offset:7168
  ds_read_b128 v[20:23], v31 offset:0
  ds_read_b128 v[36:39], v29 offset:1024
  ds_read_b128 v[40:43], v29 offset:8192
  ds_read_b128 v[16:19], v31 offset:1024
  s_waitcnt lgkmcnt(3)
  v_mfma_f32_16x16x32_bf16 v[64:67], v[172:175], v[44:47], v[64:67]
  v_mfma_f32_16x16x32_bf16 v[68:71], v[176:179], v[44:47], v[68:71]
  v_mfma_f32_16x16x32_bf16 v[72:75], v[44:47], v[180:183], v[72:75]
  v_mfma_f32_16x16x32_bf16 v[76:79], v[172:175], v[48:51], v[76:79]
  v_mfma_f32_16x16x32_bf16 v[80:83], v[176:179], v[48:51], v[80:83]
  v_mfma_f32_16x16x32_bf16 v[84:87], v[48:51], v[180:183], v[84:87]
  v_mfma_f32_16x16x32_bf16 v[32:35], v[20:23], v[20:23], v[32:35]
  ds_read_b128 v[44:47], v29 offset:2048
  ds_read_b128 v[48:51], v29 offset:9216
  ds_read_b128 v[20:23], v31 offset:2048
  s_waitcnt lgkmcnt(3)
  v_mfma_f32_16x16x32_bf16 v[64:67], v[184:187], v[36:39], v[64:67]
  v_mfma_f32_16x16x32_bf16 v[68:71], v[188:191], v[36:39], v[68:71]
  v_mfma_f32_16x16x32_bf16 v[72:75], v[36:39], v[192:195], v[72:75]
  v_mfma_f32_16x16x32_bf16 v[76:79], v[184:187], v[40:43], v[76:79]
  v_mfma_f32_16x16x32_bf16 v[80:83], v[188:191], v[40:43], v[80:83]
  v_mfma_f32_16x16x32_bf16 v[84:87], v[40:43], v[192:195], v[84:87]
  v_mfma_f32_16x16x32_bf16 v[32:35], v[16:19], v[16:19], v[32:35]
  ds_read_b128 v[36:39], v29 offset:3072
  ds_read_b128 v[40:43], v29 offset:10240
  ds_read_b128 v[16:19], v31 offset:3072
  s_waitcnt lgkmcnt(3)
  v_mfma_f32_16x16x32_bf16 v[64:67], v[196:199], v[44:47], v[64:67]
  v_mfma_f32_16x16x32_bf16 v[68:71], v[200:203], v[44:47], v[68:71]
  v_mfma_f32_16x16x32_bf16 v[72:75], v[44:47], v[204:207], v[72:75]
  v_mfma_f32_16x16x32_bf16 v[76:79], v[196:199], v[48:51], v[76:79]
  v_mfma_f32_16x16x32_bf16 v[80:83], v[200:203], v[48:51], v[80:83]
  v_mfma_f32_16x16x32_bf16 v[84:87], v[48:51], v[204:207], v[84:87]
  v_mfma_f32_16x16x32_bf16 v[32:35], v[20:23], v[20:23], v[32:35]
  s_waitcnt lgkmcnt(0)
  v_mfma_f32_16x16x32_bf16 v[64:67], v[208:211], v[36:39], v[64:67]
  v_mfma_f32_16x16x32_bf16 v[68:71], v[212:215], v[36:39], v[68:71]
  v_mfma_f32_16x16x32_bf16 v[72:75], v[36:39], v[216:219], v[72:75]
  v_mfma_f32_16x16x32_bf16 v[76:79], v[208:211], v[40:43], v[76:79]
  v_mfma_f32_16x16x32_bf16 v[80:83], v[212:215], v[40:43], v[80:83]
  v_mfma_f32_16x16x32_bf16 v[84:87], v[40:43], v[216:219], v[84:87]
  v_mfma_f32_16x16x32_bf16 v[32:35], v[16:19], v[16:19], v[32:35]
  s_waitcnt vmcnt(0)
  s_barrier
  ds_read_b128 v[44:47], v29 offset:4096
  ds_read_b128 v[48:51], v29 offset:11264
  ds_read_b128 v[20:23], v31 offset:4096
  ds_read_b128 v[36:39], v29 offset:5120
  ds_read_b128 v[40:43], v29 offset:12288
  ds_read_b128 v[16:19], v31 offset:5120
  s_waitcnt lgkmcnt(3)
  v_mfma_f32_16x16x32_bf16 v[64:67], v[220:223], v[44:47], v[64:67]
  v_mfma_f32_16x16x32_bf16 v[68:71], v[224:227], v[44:47], v[68:71]
  v_mfma_f32_16x16x32_bf16 v[72:75], v[44:47], v[228:231], v[72:75]
  v_mfma_f32_16x16x32_bf16 v[76:79], v[220:223], v[48:51], v[76:79]
  v_mfma_f32_16x16x32_bf16 v[80:83], v[224:227], v[48:51], v[80:83]
  v_mfma_f32_16x16x32_bf16 v[84:87], v[48:51], v[228:231], v[84:87]
  v_mfma_f32_16x16x32_bf16 v[32:35], v[20:23], v[20:23], v[32:35]
  ds_read_b128 v[44:47], v29 offset:6144
  ds_read_b128 v[48:51], v29 offset:13312
  ds_read_b128 v[20:23], v31 offset:6144
  s_waitcnt lgkmcnt(3)
  v_mfma_f32_16x16x32_bf16 v[64:67], v[232:235], v[36:39], v[64:67]
  v_mfma_f32_16x16x32_bf16 v[68:71], v[236:239], v[36:39], v[68:71]
  v_mfma_f32_16x16x32_bf16 v[72:75], v[36:39], v[240:243], v[72:75]
  v_mfma_f32_16x16x32_bf16 v[76:79], v[232:235], v[40:43], v[76:79]
  v_mfma_f32_16x16x32_bf16 v[80:83], v[236:239], v[40:43], v[80:83]
  v_mfma_f32_16x16x32_bf16 v[84:87], v[40:43], v[240:243], v[84:87]
  v_mfma_f32_16x16x32_bf16 v[32:35], v[16:19], v[16:19], v[32:35]
  s_waitcnt lgkmcnt(0)
  v_mfma_f32_16x16x32_bf16 v[64:67], v[244:247], v[44:47], v[64:67]
  v_mfma_f32_16x16x32_bf16 v[68:71], v[248:251], v[44:47], v[68:71]
  v_mfma_f32_16x16x32_bf16 v[72:75], v[44:47], v[252:255], v[72:75]
  v_mfma_f32_16x16x32_bf16 v[76:79], v[244:247], v[48:51], v[76:79]
  v_mfma_f32_16x16x32_bf16 v[80:83], v[248:251], v[48:51], v[80:83]
  v_mfma_f32_16x16x32_bf16 v[84:87], v[48:51], v[252:255], v[84:87]
  v_mfma_f32_16x16x32_bf16 v[32:35], v[20:23], v[20:23], v[32:35]
  v_and_b32 v3, 15, v1
  v_and_b32 v4, 3, v3
  v_lshrrev_b32 v5, 2, v3
  v_lshrrev_b32 v6, 4, v1
  v_cmp_eq_u32 s[28:29], 1, v4
  v_cmp_eq_u32 s[32:33], 2, v4
  v_cmp_eq_u32 s[34:35], 3, v4
  v_cmp_eq_u32 s[36:37], v5, v6
  v_cndmask_b32 v7, v32, v33, s[28:29]
  v_cndmask_b32 v7, v7, v34, s[32:33]
  v_cndmask_b32 v7, v7, v35, s[34:35]
  v_cndmask_b32 v7, 0, v7, s[36:37]
  s_cmp_eq_u32 s31, 0
  s_cselect_b64 vcc, -1, 0
  v_cndmask_b32 v8, v80, v68, vcc
  v_cmp_le_u32 s[28:29], 48, v1
  s_nop 1
  v_cndmask_b32 v8, 0, v8, s[28:29]
  v_mov_b32 v9, v7
  v_mov_b32 v10, v8
  s_nop 0
  v_permlane32_swap_b32 v9, v7
  v_permlane32_swap_b32 v10, v8
  v_add_f32 v7, v9, v7
  v_add_f32 v8, v10, v8
  v_mov_b32 v9, v7
  v_mov_b32 v10, v8
  s_nop 0
  v_permlane16_swap_b32 v9, v7
  v_permlane16_swap_b32 v10, v8
  v_add_f32 v7, v9, v7
  v_add_f32 v8, v10, v8
  s_mov_b32 s24, 991054117
  s_mov_b32 s25, 925353388
  v_mul_f32 v8, s24, v8
  v_mul_f32 v7, s24, v7
  v_fma_f32 v7, -v8, v8, v7
  v_max_f32 v7, 0, v7
  v_add_f32 v7, s25, v7
  v_rsq_f32 v9, v7
  s_lshr_b32 s26, s6, 1
  s_lshl_b32 s26, s26, 8
  s_add_u32 s26, s26, 143360
  s_lshl_b32 s27, s31, 7
  s_add_u32 s27, s27, s26
  v_lshlrev_b32 v3, 3, v3
  v_add_u32 v4, s27, v3
  v_add_u32 v3, s26, v3
  ds_write_b64 v4, v[8:9]
  v_lshrrev_b32 v4, 4, v1
  v_lshlrev_b32 v4, 5, v4
  v_add_u32 v4, s26, v4
  s_waitcnt lgkmcnt(0)
  s_barrier
  ds_read_b64 v[32:33], v3
  ds_read_b64 v[34:35], v3 offset:128
  ds_read_b128 v[36:39], v4
  ds_read_b128 v[40:43], v4 offset:16
  ds_read_b128 v[44:47], v4 offset:128
  ds_read_b128 v[48:51], v4 offset:144
  s_cmp_eq_u32 s31, 0
  s_cselect_b32 s25, 1049335798, 1.0
  s_cselect_b32 s27, 0x3f80, 0
  v_mov_b32 v7, s27
  v_cmp_le_u32 s[28:29], 48, v1
  s_waitcnt lgkmcnt(4)
  v_mul_f32 v5, s25, v33
  v_mul_f32 v6, s25, v35
  v_fma_f32 v64, -v32, v52, v64
  v_mul_f32 v64, v5, v64
  v_fma_f32 v65, -v32, v53, v65
  v_mul_f32 v65, v5, v65
  v_fma_f32 v66, -v32, v54, v66
  v_mul_f32 v66, v5, v66
  v_fma_f32 v67, -v32, v55, v67
  v_mul_f32 v67, v5, v67
  v_fma_f32 v68, -v32, v56, v68
  v_mul_f32 v68, v5, v68
  v_fma_f32 v69, -v32, v57, v69
  v_mul_f32 v69, v5, v69
  v_fma_f32 v70, -v32, v58, v70
  v_mul_f32 v70, v5, v70
  v_fma_f32 v71, -v32, v59, v71
  v_mul_f32 v71, v5, v71
  v_cvt_pk_bf16_f32 v8, v64, v65
  v_cvt_pk_bf16_f32 v9, v66, v67
  v_cvt_pk_bf16_f32 v10, v68, v69
  v_cvt_pk_bf16_f32 v11, v70, v71
  v_cndmask_b32 v10, v10, v7, s[28:29]
  v_cndmask_b32 v11, v11, 0, s[28:29]
  v_fma_f32 v76, -v34, v52, v76
  v_mul_f32 v76, v6, v76
  v_fma_f32 v77, -v34, v53, v77
  v_mul_f32 v77, v6, v77
  v_fma_f32 v78, -v34, v54, v78
  v_mul_f32 v78, v6, v78
  v_fma_f32 v79, -v34, v55, v79
  v_mul_f32 v79, v6, v79
  v_fma_f32 v80, -v34, v56, v80
  v_mul_f32 v80, v6, v80
  v_fma_f32 v81, -v34, v57, v81
  v_mul_f32 v81, v6, v81
  v_fma_f32 v82, -v34, v58, v82
  v_mul_f32 v82, v6, v82
  v_fma_f32 v83, -v34, v59, v83
  v_mul_f32 v83, v6, v83
  v_cvt_pk_bf16_f32 v12, v76, v77
  v_cvt_pk_bf16_f32 v13, v78, v79
  v_cvt_pk_bf16_f32 v14, v80, v81
  v_cvt_pk_bf16_f32 v15, v82, v83
  v_cndmask_b32 v14, v14, v7, s[28:29]
  v_cndmask_b32 v15, v15, 0, s[28:29]
  s_and_b32 s24, s5, 15
  s_lshl_b32 s25, s24, 7
  s_lshl_b32 s26, s4, 4
  s_add_u32 s25, s25, s26
  s_lshr_b32 s26, s5, 4
  s_lshl_b32 s26, s26, 3
  s_add_u32 s25, s25, s26
  s_lshr_b32 s26, s6, 1
  s_lshl_b32 s26, s26, 1
  s_add_u32 s25, s25, s26
  s_lshl_b32 s30, s25, 10
  s_add_u32 s30, s30, s48
  s_cmp_eq_u32 s31, 0
  s_cbranch_scc0 L_qk_20
  s_lshl_b32 s26, s26, 10
  s_add_u32 s26, s26, 57344
  v_add_u32 v3, s26, v2
  ds_write_b128 v3, v[8:11]
  ds_write_b128 v3, v[12:15] offset:1024
  s_branch L_qk_21
L_qk_20:
  s_add_u32 s27, s30, 2097152
  buffer_store_dwordx4 v[8:11], v2, s[8:11], s27 offen sc1
  buffer_store_dwordx4 v[12:15], v2, s[8:11], s27 offen offset:1024 sc1
L_qk_21:
  s_lshl_b32 s26, s31, 10
  s_add_u32 s27, s30, s26
  s_add_u32 s27, s27, 4194304
  v_and_b32 v3, 15, v1
  v_cmp_le_u32 s[28:29], 12, v3
  s_cmp_eq_u32 s31, 1
  s_cselect_b64 s[28:29], s[28:29], 0
  v_cmp_eq_u32 vcc, 12, v3
  v_mov_b32 v7, 0x3f803f80
  s_nop 0
  v_cndmask_b32 v7, 0, v7, vcc
  s_waitcnt lgkmcnt(0)
  v_fma_f32 v72, -v36, v60, v72
  v_mul_f32 v72, v37, v72
  v_fma_f32 v73, -v38, v60, v73
  v_mul_f32 v73, v39, v73
  v_fma_f32 v74, -v40, v60, v74
  v_mul_f32 v74, v41, v74
  v_fma_f32 v75, -v42, v60, v75
  v_mul_f32 v75, v43, v75
  v_cvt_pk_bf16_f32 v16, v72, v73
  v_cvt_pk_bf16_f32 v17, v74, v75
  v_cndmask_b32 v16, v16, v7, s[28:29]
  v_cndmask_b32 v17, v17, v7, s[28:29]
  v_fma_f32 v84, -v44, v60, v84
  v_mul_f32 v84, v45, v84
  v_fma_f32 v85, -v46, v60, v85
  v_mul_f32 v85, v47, v85
  v_fma_f32 v86, -v48, v60, v86
  v_mul_f32 v86, v49, v86
  v_fma_f32 v87, -v50, v60, v87
  v_mul_f32 v87, v51, v87
  v_cvt_pk_bf16_f32 v18, v84, v85
  v_cvt_pk_bf16_f32 v19, v86, v87
  v_cndmask_b32 v18, v18, v7, s[28:29]
  v_cndmask_b32 v19, v19, v7, s[28:29]
  buffer_store_dwordx4 v[16:19], v2, s[8:11], s27 offen sc1
  s_waitcnt vmcnt(0) lgkmcnt(0)
  s_barrier
  s_cmp_lg_u32 s6, 0
  s_cbranch_scc1 L_sig_22
  s_add_u32 s24, s49, 1
  s_lshl_b32 s25, s2, 7
  v_mov_b32 v4, s24
  s_mov_b64 exec, 1
  buffer_store_dword v4, off, s[8:11], s25 sc1
  s_mov_b64 exec, -1
L_sig_22:
  s_cmp_lg_u32 s7, 0
  s_cbranch_scc1 L_h_23
  s_mov_b32 s16, s64
  s_mov_b32 s17, s65
  s_mov_b32 s18, 1835008
  s_mov_b32 s19, 0x20000
  s_mul_i32 s24, s50, 57344
  s_lshl_b32 s25, s51, 7
  s_add_u32 s24, s24, s25
  s_lshl_b32 s25, s6, 4
  s_add_u32 s24, s24, s25
  s_cmp_ge_u32 s5, 28
  s_cselect_b32 s24, 0, s24
  v_mul_u32_u24 v5, 896, v1
  buffer_load_dwordx4 v[32:35], v5, s[16:19], s24 offen
  s_cmp_lg_u32 s6, 0
  s_cbranch_scc1 L_hss_27
  v_lshlrev_b32 v5, 2, v1
  s_mov_b32 s53, 0x40000
  s_mov_b32 s24, 0x80808080
L_hs_25:
  buffer_load_dword v4, v5, s[20:23], 0 offen sc1
  s_waitcnt vmcnt(0)
  v_and_b32 v6, s24, v4
  v_cmp_ne_u32 vcc, s24, v6
  s_nop 1
  s_cbranch_vccz L_hsd_26
  s_sub_u32 s53, s53, 1
  s_cmp_lg_u32 s53, 0
  s_cbranch_scc1 L_hs_25
L_hsd_26:
  v_readlane_b32 s24, v4, 0
  v_readlane_b32 s25, v4, 1
  v_and_b32 v6, 1, v1
  v_cmp_eq_u32 vcc, 0, v6
  v_mov_b32 v7, s25
  v_mov_b32 v6, s24
  v_cndmask_b32 v6, v7, v6, vcc
  v_cmp_ne_u32 vcc, v6, v4
  s_nop 0
  s_cmp_eq_u64 vcc, 0
  s_cselect_b32 s24, 1, 0
  v_mov_b32 v4, s24
  v_mov_b32 v5, 144384
  ds_write_b32 v5, v4
L_hss_27:
  s_waitcnt vmcnt(0) lgkmcnt(0)
  s_barrier
  v_mul_u32_u24 v6, 272, v1
  s_lshl_b32 s25, s6, 5
  s_add_u32 s25, s25, 146432
  v_add_u32 v6, s25, v6
  v_lshlrev_b32 v12, 16, v32
  v_and_b32 v13, 0xffff0000, v32
  v_lshlrev_b32 v14, 16, v33
  v_and_b32 v15, 0xffff0000, v33
  v_lshlrev_b32 v16, 16, v34
  v_and_b32 v17, 0xffff0000, v34
  v_lshlrev_b32 v18, 16, v35
  v_and_b32 v19, 0xffff0000, v35
  ds_write_b128 v6, v[12:15]
  ds_write_b128 v6, v[16:19] offset:16
  v_mov_b32 v5, 144384
  ds_read_b32 v4, v5
  s_waitcnt lgkmcnt(0)
  v_readfirstlane_b32 s54, v4
  s_cmp_lg_u32 s6, 0
  s_cbranch_scc1 L_tf_28
  s_lshl_b32 s25, s4, 7
  s_lshl_b32 s26, s5, 2
  s_add_u32 s25, s25, s26
  s_add_u32 s25, s25, 49152
  v_mov_b32 v4, 1
  s_mov_b64 exec, 1
  s_cmp_lg_u32 s54, 0
  s_cbranch_scc1 L_tf_29
  buffer_wbl2 sc1
  s_waitcnt vmcnt(0)
L_tf_29:
  s_cmp_eq_u32 s54, 0
  s_cbranch_scc1 L_ls_30
  buffer_store_dword v4, off, s[8:11], s25
  s_branch L_ls_31
L_ls_30:
  buffer_store_dword v4, off, s[8:11], s25 sc1
L_ls_31:
  s_mov_b64 exec, -1
L_tf_28:
L_h_23:
  s_lshl_b32 s56, s50, 18
  s_lshl_b32 s57, s6, 15
  s_add_u32 s56, s56, s57
  s_add_u32 s56, s56, 4194304
  v_and_b32 v16, 15, v1
  v_lshrrev_b32 v17, 4, v1
  v_lshlrev_b32 v17, 2, v17
  v_mov_b32 v18, 0xf149f2ca
  s_and_b32 s35, s6, 1
  s_cmp_eq_u32 s35, 0
  s_cselect_b64 s[36:37], -1, 0
  v_add_u32 v19, 0, v17
  v_cmp_gt_u32 vcc, v19, v16
  s_nop 1
  v_cndmask_b32 v20, v18, 0, vcc
  v_cndmask_b32 v21, 0, v18, vcc
  v_cndmask_b32 v32, v18, v20, s[36:37]
  v_cndmask_b32 v36, v20, 0, s[36:37]
  v_cndmask_b32 v96, 0, v21, s[36:37]
  v_cndmask_b32 v100, v21, v18, s[36:37]
  v_add_u32 v19, 1, v17
  v_cmp_gt_u32 vcc, v19, v16
  s_nop 1
  v_cndmask_b32 v20, v18, 0, vcc
  v_cndmask_b32 v21, 0, v18, vcc
  v_cndmask_b32 v33, v18, v20, s[36:37]
  v_cndmask_b32 v37, v20, 0, s[36:37]
  v_cndmask_b32 v97, 0, v21, s[36:37]
  v_cndmask_b32 v101, v21, v18, s[36:37]
  v_add_u32 v19, 2, v17
  v_cmp_gt_u32 vcc, v19, v16
  s_nop 1
  v_cndmask_b32 v20, v18, 0, vcc
  v_cndmask_b32 v21, 0, v18, vcc
  v_cndmask_b32 v34, v18, v20, s[36:37]
  v_cndmask_b32 v38, v20, 0, s[36:37]
  v_cndmask_b32 v98, 0, v21, s[36:37]
  v_cndmask_b32 v102, v21, v18, s[36:37]
  v_add_u32 v19, 3, v17
  v_cmp_gt_u32 vcc, v19, v16
  s_nop 1
  v_cndmask_b32 v20, v18, 0, vcc
  v_cndmask_b32 v21, 0, v18, vcc
  v_cndmask_b32 v35, v18, v20, s[36:37]
  v_cndmask_b32 v39, v20, 0, s[36:37]
  v_cndmask_b32 v99, 0, v21, s[36:37]
  v_cndmask_b32 v103, v21, v18, s[36:37]
  s_lshl_b32 s24, s4, 1
  s_lshr_b32 s25, s5, 4
  s_add_u32 s28, s24, s25
  s_and_b32 s29, s5, 15
  s_add_u32 s30, s49, 1
  s_lshl_b32 s33, s6, 10
  s_add_u32 s33, s33, 57344
  v_add_u32 v19, s33, v2
  ds_read_b128 v[4:7], v19
  s_cmp_lg_u32 s6, 0
  s_cbranch_scc1 L_wp_32
  v_min_u32 v3, 2, v1
  v_sub_u32 v3, s28, v3
  v_max_i32 v3, 0, v3
  v_and_b32 v22, 1, v3
  v_lshlrev_b32 v22, 4, v22
  v_add_u32 v22, s29, v22
  v_lshlrev_b32 v22, 3, v22
  v_lshrrev_b32 v3, 1, v3
  v_add_u32 v3, v3, v22
  v_lshlrev_b32 v3, 7, v3
  s_mov_b32 s53, 0x40000
L_poll_33:
  buffer_load_dword v22, v3, s[8:11], 0 offen sc1
  s_waitcnt vmcnt(0)
  v_cmp_gt_u32 vcc, s30, v22
  s_nop 1
  s_cbranch_vccz L_polld_34
  s_sub_u32 s53, s53, 1
  s_cmp_lg_u32 s53, 0
  s_cbranch_scc1 L_poll_33
L_polld_34:
L_wp_32:
  s_barrier
  s_lshl_b32 s26, s28, 3
  s_sub_u32 s26, s26, 16
  s_mul_i32 s27, s6, 3
  s_add_u32 s28, s26, s27
  s_lshl_b32 s31, s29, 7
  s_mul_i32 s32, s6, 3072
  s_add_u32 s33, s28, 0
  s_add_u32 s34, s33, s31
  s_lshl_b32 s34, s34, 10
  s_add_u32 s34, s34, s48
  s_cmp_lt_i32 s33, 0
  s_cselect_b32 s34, 0x7ff00000, s34
  s_add_u32 s38, s34, 2097152
  s_add_u32 m0, s32, 0
  s_nop 0
  buffer_load_dwordx4 v2, s[8:11], s38 offen sc1 lds
  s_add_u32 s38, s34, 4194304
  s_add_u32 m0, s32, 24576
  s_nop 0
  buffer_load_dwordx4 v2, s[8:11], s38 offen sc1 lds
  s_add_u32 s33, s28, 1
  s_add_u32 s34, s33, s31
  s_lshl_b32 s34, s34, 10
  s_add_u32 s34, s34, s48
  s_cmp_lt_i32 s33, 0
  s_cselect_b32 s34, 0x7ff00000, s34
  s_add_u32 s38, s34, 2097152
  s_add_u32 m0, s32, 1024
  s_nop 0
  buffer_load_dwordx4 v2, s[8:11], s38 offen sc1 lds
  s_add_u32 s38, s34, 4194304
  s_add_u32 m0, s32, 25600
  s_nop 0
  buffer_load_dwordx4 v2, s[8:11], s38 offen sc1 lds
  s_add_u32 s33, s28, 2
  s_add_u32 s34, s33, s31
  s_lshl_b32 s34, s34, 10
  s_add_u32 s34, s34, s48
  s_cmp_lt_i32 s33, 0
  s_cselect_b32 s34, 0x7ff00000, s34
  s_add_u32 s38, s34, 2097152
  s_add_u32 m0, s32, 2048
  s_nop 0
  buffer_load_dwordx4 v2, s[8:11], s38 offen sc1 lds
  s_add_u32 s38, s34, 4194304
  s_add_u32 m0, s32, 26624
  s_nop 0
  buffer_load_dwordx4 v2, s[8:11], s38 offen sc1 lds
  s_waitcnt vmcnt(0)
  s_cmp_ge_i32 s28, 0
  s_cbranch_scc1 L_nf_35
  v_lshlrev_b32 v19, 4, v16
  v_add_u32 v19, s32, v19
  v_mov_b32 v20, 0xf149
  s_mov_b64 exec, 0xffff
  s_add_u32 s33, s28, 0
  s_cmp_ge_i32 s33, 0
  s_cbranch_scc1 L_nf_36
  ds_write_b32 v19, v20 offset:776
L_nf_36:
  s_add_u32 s33, s28, 1
  s_cmp_ge_i32 s33, 0
  s_cbranch_scc1 L_nf_37
  ds_write_b32 v19, v20 offset:1800
L_nf_37:
  s_add_u32 s33, s28, 2
  s_cmp_ge_i32 s33, 0
  s_cbranch_scc1 L_nf_38
  ds_write_b32 v19, v20 offset:2824
L_nf_38:
  s_mov_b64 exec, -1
L_nf_35:
  s_waitcnt lgkmcnt(0)
  s_barrier
  s_lshr_b32 s33, s6, 1
  s_lshl_b32 s33, s33, 11
  v_add_u32 v19, s33, v2
  ds_read_b128 v[104:107], v19 offset:0
  ds_read_b128 v[108:111], v19 offset:1024
  ds_read_b128 v[112:115], v19 offset:2048
  ds_read_b128 v[116:119], v19 offset:3072
  ds_read_b128 v[120:123], v19 offset:4096
  ds_read_b128 v[124:127], v19 offset:5120
  s_waitcnt lgkmcnt(5)
  v_mfma_f32_16x16x32_bf16 v[32:35], v[104:107], v[4:7], v[32:35]
  ds_read_b128 v[104:107], v19 offset:6144
  s_waitcnt lgkmcnt(5)
  v_mfma_f32_16x16x32_bf16 v[36:39], v[108:111], v[4:7], v[36:39]
  ds_read_b128 v[108:111], v19 offset:7168
  s_waitcnt lgkmcnt(5)
  v_mfma_f32_16x16x32_bf16 v[40:43], v[112:115], v[4:7], 0
  ds_read_b128 v[112:115], v19 offset:8192
  s_waitcnt lgkmcnt(5)
  v_mfma_f32_16x16x32_bf16 v[44:47], v[116:119], v[4:7], 0
  ds_read_b128 v[116:119], v19 offset:9216
  s_waitcnt lgkmcnt(5)
  v_mfma_f32_16x16x32_bf16 v[48:51], v[120:123], v[4:7], 0
  ds_read_b128 v[120:123], v19 offset:10240
  s_waitcnt lgkmcnt(5)
  v_mfma_f32_16x16x32_bf16 v[52:55], v[124:127], v[4:7], 0
  ds_read_b128 v[124:127], v19 offset:11264
  s_waitcnt lgkmcnt(5)
  v_mfma_f32_16x16x32_bf16 v[56:59], v[104:107], v[4:7], 0
  ds_read_b128 v[104:107], v19 offset:12288
  s_waitcnt lgkmcnt(5)
  v_mfma_f32_16x16x32_bf16 v[60:63], v[108:111], v[4:7], 0
  ds_read_b128 v[108:111], v19 offset:13312
  s_waitcnt lgkmcnt(5)
  v_mfma_f32_16x16x32_bf16 v[64:67], v[112:115], v[4:7], 0
  ds_read_b128 v[112:115], v19 offset:14336
  s_waitcnt lgkmcnt(5)
  v_mfma_f32_16x16x32_bf16 v[68:71], v[116:119], v[4:7], 0
  ds_read_b128 v[116:119], v19 offset:15360
  s_waitcnt lgkmcnt(5)
  v_mfma_f32_16x16x32_bf16 v[72:75], v[120:123], v[4:7], 0
  ds_read_b128 v[120:123], v19 offset:16384
  s_waitcnt lgkmcnt(5)
  v_mfma_f32_16x16x32_bf16 v[76:79], v[124:127], v[4:7], 0
  ds_read_b128 v[124:127], v19 offset:17408
  s_waitcnt lgkmcnt(5)
  v_mfma_f32_16x16x32_bf16 v[80:83], v[104:107], v[4:7], 0
  ds_read_b128 v[104:107], v19 offset:24576
  s_waitcnt lgkmcnt(5)
  v_mfma_f32_16x16x32_bf16 v[84:87], v[108:111], v[4:7], 0
  ds_read_b128 v[108:111], v19 offset:25600
  s_waitcnt lgkmcnt(5)
  v_mfma_f32_16x16x32_bf16 v[88:91], v[112:115], v[4:7], 0
  ds_read_b128 v[112:115], v19 offset:26624
  s_waitcnt lgkmcnt(5)
  v_mfma_f32_16x16x32_bf16 v[92:95], v[116:119], v[4:7], 0
  ds_read_b128 v[116:119], v19 offset:27648
  s_waitcnt lgkmcnt(5)
  v_mfma_f32_16x16x32_bf16 v[96:99], v[120:123], v[4:7], v[96:99]
  ds_read_b128 v[120:123], v19 offset:28672
  s_waitcnt lgkmcnt(5)
  v_mfma_f32_16x16x32_bf16 v[100:103], v[124:127], v[4:7], v[100:103]
  ds_read_b128 v[124:127], v19 offset:29696
  v_max3_f32 v20, v32, v33, v34
  v_max3_f32 v21, v35, v36, v37
  v_max3_f32 v20, v20, v38, v39
  v_max3_f32 v21, v21, v40, v41
  v_max3_f32 v20, v20, v42, v43
  v_max3_f32 v21, v21, v44, v45
  v_max3_f32 v20, v20, v46, v47
  v_max3_f32 v21, v21, v48, v49
  v_max3_f32 v20, v20, v50, v51
  v_max3_f32 v21, v21, v52, v53
  v_max3_f32 v20, v20, v54, v55
  v_max3_f32 v21, v21, v56, v57
  v_max3_f32 v20, v20, v58, v59
  v_max3_f32 v21, v21, v60, v61
  v_max3_f32 v20, v20, v62, v63
  v_max3_f32 v21, v21, v64, v65
  v_max3_f32 v20, v20, v66, v67
  v_max3_f32 v21, v21, v68, v69
  v_max3_f32 v20, v20, v70, v71
  v_max3_f32 v21, v21, v72, v73
  v_max3_f32 v20, v20, v74, v75
  v_max3_f32 v21, v21, v76, v77
  v_max3_f32 v20, v20, v78, v79
  v_max3_f32 v21, v21, v80, v81
  v_max3_f32 v20, v20, v82, v83
  v_max3_f32 v21, v21, v84, v85
  v_max3_f32 v20, v20, v86, v87
  v_max3_f32 v21, v21, v88, v89
  v_max3_f32 v20, v20, v90, v91
  v_max3_f32 v21, v21, v92, v93
  v_max3_f32 v20, v20, v94, v95
  v_max3_f32 v21, v21, v96, v97
  v_max3_f32 v20, v20, v98, v99
  v_max3_f32 v21, v21, v100, v101
  v_max3_f32 v20, v20, v102, v103
  v_max_f32 v20, v20, v21
  v_mov_b32 v21, v20
  s_nop 1
  v_permlane32_swap_b32 v21, v20
  v_max_f32 v20, v21, v20
  v_mov_b32 v21, v20
  s_nop 1
  v_permlane16_swap_b32 v21, v20
  v_max_f32 v20, v21, v20
  v_mov_b32 v21, v20
  v_pk_add_f32 v[32:33], v[32:33], v[20:21] neg_lo:[0,1] neg_hi:[0,1]
  v_pk_add_f32 v[34:35], v[34:35], v[20:21] neg_lo:[0,1] neg_hi:[0,1]
  v_pk_add_f32 v[36:37], v[36:37], v[20:21] neg_lo:[0,1] neg_hi:[0,1]
  v_pk_add_f32 v[38:39], v[38:39], v[20:21] neg_lo:[0,1] neg_hi:[0,1]
  v_exp_f32 v32, v32
  v_exp_f32 v33, v33
  v_exp_f32 v34, v34
  v_exp_f32 v35, v35
  v_exp_f32 v36, v36
  v_exp_f32 v37, v37
  v_exp_f32 v38, v38
  v_exp_f32 v39, v39
  v_cvt_pk_bf16_f32 v32, v32, v33
  v_cvt_pk_bf16_f32 v33, v34, v35
  v_cvt_pk_bf16_f32 v34, v36, v37
  v_cvt_pk_bf16_f32 v35, v38, v39
  s_waitcnt lgkmcnt(5)
  s_nop 0
  v_mfma_f32_16x16x32_bf16 v[8:11], v[104:107], v[32:35], 0
  ds_read_b128 v[104:107], v19 offset:30720
  s_waitcnt lgkmcnt(5)
  v_mfma_f32_16x16x32_bf16 v[12:15], v[108:111], v[32:35], 0
  ds_read_b128 v[108:111], v19 offset:31744
  v_pk_add_f32 v[40:41], v[40:41], v[20:21] neg_lo:[0,1] neg_hi:[0,1]
  v_pk_add_f32 v[42:43], v[42:43], v[20:21] neg_lo:[0,1] neg_hi:[0,1]
  v_pk_add_f32 v[44:45], v[44:45], v[20:21] neg_lo:[0,1] neg_hi:[0,1]
  v_pk_add_f32 v[46:47], v[46:47], v[20:21] neg_lo:[0,1] neg_hi:[0,1]
  v_exp_f32 v40, v40
  v_exp_f32 v41, v41
  v_exp_f32 v42, v42
  v_exp_f32 v43, v43
  v_exp_f32 v44, v44
  v_exp_f32 v45, v45
  v_exp_f32 v46, v46
  v_exp_f32 v47, v47
  v_cvt_pk_bf16_f32 v40, v40, v41
  v_cvt_pk_bf16_f32 v41, v42, v43
  v_cvt_pk_bf16_f32 v42, v44, v45
  v_cvt_pk_bf16_f32 v43, v46, v47
  s_waitcnt lgkmcnt(5)
  s_nop 0
  v_mfma_f32_16x16x32_bf16 v[8:11], v[112:115], v[40:43], v[8:11]
  ds_read_b128 v[112:115], v19 offset:32768
  s_waitcnt lgkmcnt(5)
  v_mfma_f32_16x16x32_bf16 v[12:15], v[116:119], v[40:43], v[12:15]
  ds_read_b128 v[116:119], v19 offset:33792
  s_cmp_ge_u32 s5, 28
  s_cbranch_scc1 L_am_39
  s_mov_b32 s12, s68
  s_mov_b32 s13, s69
  s_mov_b32 s14, 401408
  s_mov_b32 s15, 0x20000
  v_lshrrev_b32 v23, 3, v1
  v_and_b32 v24, 7, v1
  v_bfe_u32 v25, v23, 1, 2
  v_lshlrev_b32 v25, 1, v25
  v_xor_b32 v24, v24, v25
  v_mul_u32_u24 v25, 896, v23
  v_lshl_add_u32 v26, v24, 4, v25
  v_mov_b32 v24, 0x7ff00000
  v_cmp_le_u32 vcc, 4, v23
  s_mul_i32 s24, s6, 50176
  s_lshl_b32 s25, s51, 7
  v_cndmask_b32 v27, v26, v24, vcc
  s_add_u32 s24, s24, s25
  s_lshl_b32 s26, s6, 13
  s_add_u32 s26, s26, 65536
  s_add_u32 m0, s26, 0
  s_add_u32 s27, s24, 0
  buffer_load_dwordx4 v26, s[12:15], s27 offen lds
  s_add_u32 m0, s26, 1024
  s_add_u32 s27, s24, 7168
  buffer_load_dwordx4 v26, s[12:15], s27 offen lds
  s_add_u32 m0, s26, 2048
  s_add_u32 s27, s24, 14336
  buffer_load_dwordx4 v26, s[12:15], s27 offen lds
  s_add_u32 m0, s26, 3072
  s_add_u32 s27, s24, 21504
  buffer_load_dwordx4 v27, s[12:15], s27 offen lds
  s_add_u32 m0, s26, 4096
  s_add_u32 s27, s24, 25088
  buffer_load_dwordx4 v26, s[12:15], s27 offen lds
  s_add_u32 m0, s26, 5120
  s_add_u32 s27, s24, 32256
  buffer_load_dwordx4 v26, s[12:15], s27 offen lds
  s_add_u32 m0, s26, 6144
  s_add_u32 s27, s24, 39424
  buffer_load_dwordx4 v26, s[12:15], s27 offen lds
  s_add_u32 m0, s26, 7168
  s_add_u32 s27, s24, 46592
  buffer_load_dwordx4 v27, s[12:15], s27 offen lds
L_am_39:
  s_cmp_lg_u32 s7, 0
  s_cbranch_scc1 L_am_40
  s_lshl_b32 s24, s4, 7
  s_add_u32 s24, s24, 49152
  v_and_b32 v3, 31, v1
  v_lshlrev_b32 v3, 2, v3
  v_add_u32 v3, s24, v3
  s_mov_b32 s53, 0x40000
L_poll_41:
  buffer_load_dword v22, v3, s[8:11], 0 offen sc1
  s_waitcnt vmcnt(0)
  v_cmp_gt_u32 vcc, 1, v22
  s_nop 1
  s_cbranch_vccz L_polld_42
  s_sub_u32 s53, s53, 1
  s_cmp_lg_u32 s53, 0
  s_cbranch_scc1 L_poll_41
L_polld_42:
  s_cmp_lg_u32 s54, 0
  s_cbranch_scc1 L_am_43
  buffer_inv sc1
  s_waitcnt vmcnt(0)
L_am_43:
L_am_40:
  v_pk_add_f32 v[48:49], v[48:49], v[20:21] neg_lo:[0,1] neg_hi:[0,1]
  v_pk_add_f32 v[50:51], v[50:51], v[20:21] neg_lo:[0,1] neg_hi:[0,1]
  v_pk_add_f32 v[52:53], v[52:53], v[20:21] neg_lo:[0,1] neg_hi:[0,1]
  v_pk_add_f32 v[54:55], v[54:55], v[20:21] neg_lo:[0,1] neg_hi:[0,1]
  v_exp_f32 v48, v48
  v_exp_f32 v49, v49
  v_exp_f32 v50, v50
  v_exp_f32 v51, v51
  v_exp_f32 v52, v52
  v_exp_f32 v53, v53
  v_exp_f32 v54, v54
  v_exp_f32 v55, v55
  v_cvt_pk_bf16_f32 v48, v48, v49
  v_cvt_pk_bf16_f32 v49, v50, v51
  v_cvt_pk_bf16_f32 v50, v52, v53
  v_cvt_pk_bf16_f32 v51, v54, v55
  s_waitcnt lgkmcnt(5)
  s_nop 0
  v_mfma_f32_16x16x32_bf16 v[8:11], v[120:123], v[48:51], v[8:11]
  ds_read_b128 v[120:123], v19 offset:34816
  s_waitcnt lgkmcnt(5)
  v_mfma_f32_16x16x32_bf16 v[12:15], v[124:127], v[48:51], v[12:15]
  ds_read_b128 v[124:127], v19 offset:35840
  buffer_load_dwordx4 v[128:131], v2, s[8:11], s56 offen offset:0 sc1
  buffer_load_dwordx4 v[132:135], v2, s[8:11], s56 offen offset:1024 sc1
  v_pk_add_f32 v[56:57], v[56:57], v[20:21] neg_lo:[0,1] neg_hi:[0,1]
  v_pk_add_f32 v[58:59], v[58:59], v[20:21] neg_lo:[0,1] neg_hi:[0,1]
  v_pk_add_f32 v[60:61], v[60:61], v[20:21] neg_lo:[0,1] neg_hi:[0,1]
  v_pk_add_f32 v[62:63], v[62:63], v[20:21] neg_lo:[0,1] neg_hi:[0,1]
  v_exp_f32 v56, v56
  v_exp_f32 v57, v57
  v_exp_f32 v58, v58
  v_exp_f32 v59, v59
  v_exp_f32 v60, v60
  v_exp_f32 v61, v61
  v_exp_f32 v62, v62
  v_exp_f32 v63, v63
  v_cvt_pk_bf16_f32 v56, v56, v57
  v_cvt_pk_bf16_f32 v57, v58, v59
  v_cvt_pk_bf16_f32 v58, v60, v61
  v_cvt_pk_bf16_f32 v59, v62, v63
  s_waitcnt lgkmcnt(5)
  s_nop 0
  v_mfma_f32_16x16x32_bf16 v[8:11], v[104:107], v[56:59], v[8:11]
  ds_read_b128 v[104:107], v19 offset:36864
  s_waitcnt lgkmcnt(5)
  v_mfma_f32_16x16x32_bf16 v[12:15], v[108:111], v[56:59], v[12:15]
  ds_read_b128 v[108:111], v19 offset:37888
  buffer_load_dwordx4 v[136:139], v2, s[8:11], s56 offen offset:2048 sc1
  buffer_load_dwordx4 v[140:143], v2, s[8:11], s56 offen offset:3072 sc1
  s_add_u32 s56, s56, 4096
  v_pk_add_f32 v[64:65], v[64:65], v[20:21] neg_lo:[0,1] neg_hi:[0,1]
  v_pk_add_f32 v[66:67], v[66:67], v[20:21] neg_lo:[0,1] neg_hi:[0,1]
  v_pk_add_f32 v[68:69], v[68:69], v[20:21] neg_lo:[0,1] neg_hi:[0,1]
  v_pk_add_f32 v[70:71], v[70:71], v[20:21] neg_lo:[0,1] neg_hi:[0,1]
  v_exp_f32 v64, v64
  v_exp_f32 v65, v65
  v_exp_f32 v66, v66
  v_exp_f32 v67, v67
  v_exp_f32 v68, v68
  v_exp_f32 v69, v69
  v_exp_f32 v70, v70
  v_exp_f32 v71, v71
  v_cvt_pk_bf16_f32 v64, v64, v65
  v_cvt_pk_bf16_f32 v65, v66, v67
  v_cvt_pk_bf16_f32 v66, v68, v69
  v_cvt_pk_bf16_f32 v67, v70, v71
  s_waitcnt lgkmcnt(5)
  s_nop 0
  v_mfma_f32_16x16x32_bf16 v[8:11], v[112:115], v[64:67], v[8:11]
  ds_read_b128 v[112:115], v19 offset:38912
  s_waitcnt lgkmcnt(5)
  v_mfma_f32_16x16x32_bf16 v[12:15], v[116:119], v[64:67], v[12:15]
  ds_read_b128 v[116:119], v19 offset:39936
  buffer_load_dwordx4 v[144:147], v2, s[8:11], s56 offen offset:0 sc1
  buffer_load_dwordx4 v[148:151], v2, s[8:11], s56 offen offset:1024 sc1
  v_pk_add_f32 v[72:73], v[72:73], v[20:21] neg_lo:[0,1] neg_hi:[0,1]
  v_pk_add_f32 v[74:75], v[74:75], v[20:21] neg_lo:[0,1] neg_hi:[0,1]
  v_pk_add_f32 v[76:77], v[76:77], v[20:21] neg_lo:[0,1] neg_hi:[0,1]
  v_pk_add_f32 v[78:79], v[78:79], v[20:21] neg_lo:[0,1] neg_hi:[0,1]
  v_exp_f32 v72, v72
  v_exp_f32 v73, v73
  v_exp_f32 v74, v74
  v_exp_f32 v75, v75
  v_exp_f32 v76, v76
  v_exp_f32 v77, v77
  v_exp_f32 v78, v78
  v_exp_f32 v79, v79
  v_cvt_pk_bf16_f32 v72, v72, v73
  v_cvt_pk_bf16_f32 v73, v74, v75
  v_cvt_pk_bf16_f32 v74, v76, v77
  v_cvt_pk_bf16_f32 v75, v78, v79
  s_waitcnt lgkmcnt(5)
  s_nop 0
  v_mfma_f32_16x16x32_bf16 v[8:11], v[120:123], v[72:75], v[8:11]
  ds_read_b128 v[120:123], v19 offset:40960
  s_waitcnt lgkmcnt(5)
  v_mfma_f32_16x16x32_bf16 v[12:15], v[124:127], v[72:75], v[12:15]
  ds_read_b128 v[124:127], v19 offset:41984
  buffer_load_dwordx4 v[152:155], v2, s[8:11], s56 offen offset:2048 sc1
  buffer_load_dwordx4 v[156:159], v2, s[8:11], s56 offen offset:3072 sc1
  s_add_u32 s56, s56, 4096
  v_pk_add_f32 v[80:81], v[80:81], v[20:21] neg_lo:[0,1] neg_hi:[0,1]
  v_pk_add_f32 v[82:83], v[82:83], v[20:21] neg_lo:[0,1] neg_hi:[0,1]
  v_pk_add_f32 v[84:85], v[84:85], v[20:21] neg_lo:[0,1] neg_hi:[0,1]
  v_pk_add_f32 v[86:87], v[86:87], v[20:21] neg_lo:[0,1] neg_hi:[0,1]
  v_exp_f32 v80, v80
  v_exp_f32 v81, v81
  v_exp_f32 v82, v82
  v_exp_f32 v83, v83
  v_exp_f32 v84, v84
  v_exp_f32 v85, v85
  v_exp_f32 v86, v86
  v_exp_f32 v87, v87
  v_cvt_pk_bf16_f32 v80, v80, v81
  v_cvt_pk_bf16_f32 v81, v82, v83
  v_cvt_pk_bf16_f32 v82, v84, v85
  v_cvt_pk_bf16_f32 v83, v86, v87
  s_waitcnt lgkmcnt(5)
  s_nop 0
  v_mfma_f32_16x16x32_bf16 v[8:11], v[104:107], v[80:83], v[8:11]
  s_waitcnt lgkmcnt(4)
  v_mfma_f32_16x16x32_bf16 v[12:15], v[108:111], v[80:83], v[12:15]
  buffer_load_dwordx4 v[160:163], v2, s[8:11], s56 offen offset:0 sc1
  buffer_load_dwordx4 v[164:167], v2, s[8:11], s56 offen offset:1024 sc1
  v_pk_add_f32 v[88:89], v[88:89], v[20:21] neg_lo:[0,1] neg_hi:[0,1]
  v_pk_add_f32 v[90:91], v[90:91], v[20:21] neg_lo:[0,1] neg_hi:[0,1]
  v_pk_add_f32 v[92:93], v[92:93], v[20:21] neg_lo:[0,1] neg_hi:[0,1]
  v_pk_add_f32 v[94:95], v[94:95], v[20:21] neg_lo:[0,1] neg_hi:[0,1]
  v_exp_f32 v88, v88
  v_exp_f32 v89, v89
  v_exp_f32 v90, v90
  v_exp_f32 v91, v91
  v_exp_f32 v92, v92
  v_exp_f32 v93, v93
  v_exp_f32 v94, v94
  v_exp_f32 v95, v95
  v_cvt_pk_bf16_f32 v88, v88, v89
  v_cvt_pk_bf16_f32 v89, v90, v91
  v_cvt_pk_bf16_f32 v90, v92, v93
  v_cvt_pk_bf16_f32 v91, v94, v95
  s_waitcnt lgkmcnt(3)
  s_nop 0
  v_mfma_f32_16x16x32_bf16 v[8:11], v[112:115], v[88:91], v[8:11]
  s_waitcnt lgkmcnt(2)
  v_mfma_f32_16x16x32_bf16 v[12:15], v[116:119], v[88:91], v[12:15]
  buffer_load_dwordx4 v[168:171], v2, s[8:11], s56 offen offset:2048 sc1
  buffer_load_dwordx4 v[172:175], v2, s[8:11], s56 offen offset:3072 sc1
  s_add_u32 s56, s56, 4096
  v_pk_add_f32 v[96:97], v[96:97], v[20:21] neg_lo:[0,1] neg_hi:[0,1]
  v_pk_add_f32 v[98:99], v[98:99], v[20:21] neg_lo:[0,1] neg_hi:[0,1]
  v_pk_add_f32 v[100:101], v[100:101], v[20:21] neg_lo:[0,1] neg_hi:[0,1]
  v_pk_add_f32 v[102:103], v[102:103], v[20:21] neg_lo:[0,1] neg_hi:[0,1]
  v_exp_f32 v96, v96
  v_exp_f32 v97, v97
  v_exp_f32 v98, v98
  v_exp_f32 v99, v99
  v_exp_f32 v100, v100
  v_exp_f32 v101, v101
  v_exp_f32 v102, v102
  v_exp_f32 v103, v103
  v_cvt_pk_bf16_f32 v96, v96, v97
  v_cvt_pk_bf16_f32 v97, v98, v99
  v_cvt_pk_bf16_f32 v98, v100, v101
  v_cvt_pk_bf16_f32 v99, v102, v103
  s_waitcnt lgkmcnt(1)
  s_nop 0
  v_mfma_f32_16x16x32_bf16 v[8:11], v[120:123], v[96:99], v[8:11]
  s_waitcnt lgkmcnt(0)
  v_mfma_f32_16x16x32_bf16 v[12:15], v[124:127], v[96:99], v[12:15]
  s_nop 7
  v_mov_b32 v21, v12
  v_mov_b32 v22, v12
  s_nop 1
  v_permlane32_swap_b32 v21, v22
  v_mov_b32 v21, v22
  s_nop 1
  v_permlane16_swap_b32 v21, v22
  v_rcp_f32 v22, v22
  s_nop 0
  v_mul_f32 v8, v8, v22
  v_mul_f32 v9, v9, v22
  v_mul_f32 v10, v10, v22
  v_mul_f32 v11, v11, v22
  v_mul_f32 v12, v12, v22
  v_mul_f32 v13, v13, v22
  v_mul_f32 v14, v14, v22
  v_mul_f32 v15, v15, v22
  v_cvt_pk_bf16_f32 v24, v8, v9
  v_cvt_pk_bf16_f32 v25, v10, v11
  v_cvt_pk_bf16_f32 v26, v12, v13
  v_cvt_pk_bf16_f32 v27, v14, v15
  s_lshl_b32 s24, s4, 1
  s_lshr_b32 s25, s5, 4
  s_add_u32 s24, s24, s25
  s_lshl_b32 s24, s24, 3
  s_add_u32 s24, s24, s6
  s_lshl_b32 s33, s24, 4
  s_add_u32 s33, s33, s29
  s_lshl_b32 s33, s33, 10
  s_add_u32 s33, s33, s48
  s_add_u32 s33, s33, 6291456
  s_cmp_eq_u32 s54, 0
  s_cbranch_scc1 L_ls_44
  buffer_store_dwordx4 v[24:27], v2, s[8:11], s33 offen
  s_branch L_ls_45
L_ls_44:
  buffer_store_dwordx4 v[24:27], v2, s[8:11], s33 offen sc1
L_ls_45:
  s_waitcnt vmcnt(0) lgkmcnt(0)
  s_barrier
  s_cmp_lg_u32 s6, 0
  s_cbranch_scc1 L_sig_46
  s_add_u32 s24, s49, 2
  s_lshl_b32 s25, s4, 7
  s_lshl_b32 s26, s5, 2
  s_add_u32 s25, s25, s26
  s_add_u32 s25, s25, 49152
  v_mov_b32 v4, s24
  s_mov_b64 exec, 1
  s_cmp_eq_u32 s54, 0
  s_cbranch_scc1 L_ls_47
  buffer_store_dword v4, off, s[8:11], s25
  s_branch L_ls_48
L_ls_47:
  buffer_store_dword v4, off, s[8:11], s25 sc1
L_ls_48:
  s_mov_b64 exec, -1
L_sig_46:
  s_cmp_ge_u32 s5, 28
  s_cbranch_scc1 L_idle
  s_and_b32 s24, s6, 3
  s_lshl_b32 s25, s50, 2
  s_add_u32 s30, s24, s25
  s_lshr_b32 s31, s6, 2
  s_lshl_b32 s28, s31, 3
  s_add_u32 s32, s49, 2
  v_lshrrev_b32 v3, 4, v1
  v_bfe_u32 v4, v1, 2, 2
  v_lshl_add_u32 v5, v3, 2, v4
  v_bfe_u32 v6, v5, 1, 2
  v_lshlrev_b32 v5, 7, v5
  v_and_b32 v7, 1, v1
  v_lshl_add_u32 v5, v7, 3, v5
  v_bfe_u32 v7, v1, 1, 1
  v_lshl_add_u32 v5, v7, 4, v5
  s_lshl_b32 s24, s31, 15
  s_add_u32 s24, s24, 65536
  v_add_u32 v5, s24, v5
  v_xor_b32 v7, 0, v6
  v_lshl_add_u32 v8, v7, 5, v5
  v_xor_b32 v7, 1, v6
  v_lshl_add_u32 v9, v7, 5, v5
  v_xor_b32 v7, 2, v6
  v_lshl_add_u32 v10, v7, 5, v5
  v_xor_b32 v7, 3, v6
  v_lshl_add_u32 v11, v7, 5, v5
  s_lshl_b32 s33, s30, 4
  s_add_u32 s33, s33, s28
  s_lshl_b32 s33, s33, 10
  s_add_u32 s33, s33, s48
  s_add_u32 s33, s33, 6291456
  ds_read_b64_tr_b16 v[32:33], v8 offset:0
  ds_read_b64_tr_b16 v[34:35], v8 offset:2048
  ds_read_b64_tr_b16 v[36:37], v9 offset:0
  ds_read_b64_tr_b16 v[38:39], v9 offset:2048
  ds_read_b64_tr_b16 v[40:41], v10 offset:0
  ds_read_b64_tr_b16 v[42:43], v10 offset:2048
  ds_read_b64_tr_b16 v[44:45], v11 offset:0
  ds_read_b64_tr_b16 v[46:47], v11 offset:2048
  ds_read_b64_tr_b16 v[48:49], v8 offset:4096
  ds_read_b64_tr_b16 v[50:51], v8 offset:6144
  ds_read_b64_tr_b16 v[52:53], v9 offset:4096
  ds_read_b64_tr_b16 v[54:55], v9 offset:6144
  ds_read_b64_tr_b16 v[56:57], v10 offset:4096
  ds_read_b64_tr_b16 v[58:59], v10 offset:6144
  s_cmp_lg_u32 s6, 0
  s_cbranch_scc1 L_wp_49
  s_lshr_b32 s26, s50, 1
  s_and_b32 s27, s26, 1
  s_lshl_b32 s27, s27, 4
  v_and_b32 v3, 15, v1
  v_add_u32 v3, s27, v3
  v_lshlrev_b32 v3, 2, v3
  s_lshl_b32 s26, s4, 7
  s_add_u32 s26, s26, 49152
  v_add_u32 v3, s26, v3
  s_mov_b32 s53, 0x40000
L_poll_50:
  buffer_load_dword v4, v3, s[8:11], 0 offen sc1
  s_waitcnt vmcnt(0)
  v_cmp_gt_u32 vcc, s32, v4
  s_nop 1
  s_cbranch_vccz L_polld_51
  s_sub_u32 s53, s53, 1
  s_cmp_lg_u32 s53, 0
  s_cbranch_scc1 L_poll_50
L_polld_51:
L_wp_49:
  s_barrier
  s_add_u32 s34, s33, 0
  buffer_load_dwordx4 v[64:67], v2, s[8:11], s34 offen sc1
  s_add_u32 s34, s33, 1024
  buffer_load_dwordx4 v[68:71], v2, s[8:11], s34 offen sc1
  s_add_u32 s34, s33, 2048
  buffer_load_dwordx4 v[72:75], v2, s[8:11], s34 offen sc1
  s_add_u32 s34, s33, 3072
  buffer_load_dwordx4 v[76:79], v2, s[8:11], s34 offen sc1
  s_add_u32 s34, s33, 4096
  buffer_load_dwordx4 v[80:83], v2, s[8:11], s34 offen sc1
  s_add_u32 s34, s33, 5120
  buffer_load_dwordx4 v[84:87], v2, s[8:11], s34 offen sc1
  s_add_u32 s34, s33, 6144
  buffer_load_dwordx4 v[88:91], v2, s[8:11], s34 offen sc1
  s_add_u32 s34, s33, 7168
  buffer_load_dwordx4 v[92:95], v2, s[8:11], s34 offen sc1
  s_waitcnt vmcnt(7)
  s_waitcnt lgkmcnt(12)
  v_mfma_f32_16x16x32_bf16 v[96:99], v[64:67], v[32:35], 0
  ds_read_b64_tr_b16 v[32:33], v11 offset:4096
  ds_read_b64_tr_b16 v[34:35], v11 offset:6144
  s_waitcnt lgkmcnt(12)
  v_mfma_f32_16x16x32_bf16 v[100:103], v[64:67], v[36:39], 0
  ds_read_b64_tr_b16 v[36:37], v8 offset:8192
  ds_read_b64_tr_b16 v[38:39], v8 offset:10240
  s_waitcnt lgkmcnt(12)
  v_mfma_f32_16x16x32_bf16 v[104:107], v[64:67], v[40:43], 0
  ds_read_b64_tr_b16 v[40:41], v9 offset:8192
  ds_read_b64_tr_b16 v[42:43], v9 offset:10240
  s_waitcnt lgkmcnt(12)
  v_mfma_f32_16x16x32_bf16 v[108:111], v[64:67], v[44:47], 0
  ds_read_b64_tr_b16 v[44:45], v10 offset:8192
  ds_read_b64_tr_b16 v[46:47], v10 offset:10240
  s_waitcnt vmcnt(6)
  s_waitcnt lgkmcnt(12)
  v_mfma_f32_16x16x32_bf16 v[96:99], v[68:71], v[48:51], v[96:99]
  ds_read_b64_tr_b16 v[48:49], v11 offset:8192
  ds_read_b64_tr_b16 v[50:51], v11 offset:10240
  s_waitcnt lgkmcnt(12)
  v_mfma_f32_16x16x32_bf16 v[100:103], v[68:71], v[52:55], v[100:103]
  ds_read_b64_tr_b16 v[52:53], v8 offset:12288
  ds_read_b64_tr_b16 v[54:55], v8 offset:14336
  s_waitcnt lgkmcnt(12)
  v_mfma_f32_16x16x32_bf16 v[104:107], v[68:71], v[56:59], v[104:107]
  ds_read_b64_tr_b16 v[56:57], v9 offset:12288
  ds_read_b64_tr_b16 v[58:59], v9 offset:14336
  s_waitcnt lgkmcnt(12)
  v_mfma_f32_16x16x32_bf16 v[108:111], v[68:71], v[32:35], v[108:111]
  ds_read_b64_tr_b16 v[32:33], v10 offset:12288
  ds_read_b64_tr_b16 v[34:35], v10 offset:14336
  s_waitcnt vmcnt(5)
  s_waitcnt lgkmcnt(12)
  v_mfma_f32_16x16x32_bf16 v[96:99], v[72:75], v[36:39], v[96:99]
  ds_read_b64_tr_b16 v[36:37], v11 offset:12288
  ds_read_b64_tr_b16 v[38:39], v11 offset:14336
  s_waitcnt lgkmcnt(12)
  v_mfma_f32_16x16x32_bf16 v[100:103], v[72:75], v[40:43], v[100:103]
  ds_read_b64_tr_b16 v[40:41], v8 offset:16384
  ds_read_b64_tr_b16 v[42:43], v8 offset:18432
  s_waitcnt lgkmcnt(12)
  v_mfma_f32_16x16x32_bf16 v[104:107], v[72:75], v[44:47], v[104:107]
  ds_read_b64_tr_b16 v[44:45], v9 offset:16384
  ds_read_b64_tr_b16 v[46:47], v9 offset:18432
  s_waitcnt lgkmcnt(12)
  v_mfma_f32_16x16x32_bf16 v[108:111], v[72:75], v[48:51], v[108:111]
  ds_read_b64_tr_b16 v[48:49], v10 offset:16384
  ds_read_b64_tr_b16 v[50:51], v10 offset:18432
  s_waitcnt vmcnt(4)
  s_waitcnt lgkmcnt(12)
  v_mfma_f32_16x16x32_bf16 v[96:99], v[76:79], v[52:55], v[96:99]
  ds_read_b64_tr_b16 v[52:53], v11 offset:16384
  ds_read_b64_tr_b16 v[54:55], v11 offset:18432
  s_waitcnt lgkmcnt(12)
  v_mfma_f32_16x16x32_bf16 v[100:103], v[76:79], v[56:59], v[100:103]
  ds_read_b64_tr_b16 v[56:57], v8 offset:20480
  ds_read_b64_tr_b16 v[58:59], v8 offset:22528
  s_waitcnt lgkmcnt(12)
  v_mfma_f32_16x16x32_bf16 v[104:107], v[76:79], v[32:35], v[104:107]
  ds_read_b64_tr_b16 v[32:33], v9 offset:20480
  ds_read_b64_tr_b16 v[34:35], v9 offset:22528
  s_waitcnt lgkmcnt(12)
  v_mfma_f32_16x16x32_bf16 v[108:111], v[76:79], v[36:39], v[108:111]
  ds_read_b64_tr_b16 v[36:37], v10 offset:20480
  ds_read_b64_tr_b16 v[38:39], v10 offset:22528
  s_waitcnt vmcnt(3)
  s_waitcnt lgkmcnt(12)
  v_mfma_f32_16x16x32_bf16 v[96:99], v[80:83], v[40:43], v[96:99]
  ds_read_b64_tr_b16 v[40:41], v11 offset:20480
  ds_read_b64_tr_b16 v[42:43], v11 offset:22528
  s_waitcnt lgkmcnt(12)
  v_mfma_f32_16x16x32_bf16 v[100:103], v[80:83], v[44:47], v[100:103]
  ds_read_b64_tr_b16 v[44:45], v8 offset:24576
  ds_read_b64_tr_b16 v[46:47], v8 offset:26624
  s_waitcnt lgkmcnt(12)
  v_mfma_f32_16x16x32_bf16 v[104:107], v[80:83], v[48:51], v[104:107]
  ds_read_b64_tr_b16 v[48:49], v9 offset:24576
  ds_read_b64_tr_b16 v[50:51], v9 offset:26624
  s_waitcnt lgkmcnt(12)
  v_mfma_f32_16x16x32_bf16 v[108:111], v[80:83], v[52:55], v[108:111]
  ds_read_b64_tr_b16 v[52:53], v10 offset:24576
  ds_read_b64_tr_b16 v[54:55], v10 offset:26624
  s_waitcnt vmcnt(2)
  s_waitcnt lgkmcnt(12)
  v_mfma_f32_16x16x32_bf16 v[96:99], v[84:87], v[56:59], v[96:99]
  ds_read_b64_tr_b16 v[56:57], v11 offset:24576
  ds_read_b64_tr_b16 v[58:59], v11 offset:26624
  s_waitcnt lgkmcnt(12)
  v_mfma_f32_16x16x32_bf16 v[100:103], v[84:87], v[32:35], v[100:103]
  ds_read_b64_tr_b16 v[32:33], v8 offset:28672
  ds_read_b64_tr_b16 v[34:35], v8 offset:30720
  s_waitcnt lgkmcnt(12)
  v_mfma_f32_16x16x32_bf16 v[104:107], v[84:87], v[36:39], v[104:107]
  ds_read_b64_tr_b16 v[36:37], v9 offset:28672
  ds_read_b64_tr_b16 v[38:39], v9 offset:30720
  s_waitcnt lgkmcnt(12)
  v_mfma_f32_16x16x32_bf16 v[108:111], v[84:87], v[40:43], v[108:111]
  ds_read_b64_tr_b16 v[40:41], v10 offset:28672
  ds_read_b64_tr_b16 v[42:43], v10 offset:30720
  s_waitcnt vmcnt(1)
  s_waitcnt lgkmcnt(12)
  v_mfma_f32_16x16x32_bf16 v[96:99], v[88:91], v[44:47], v[96:99]
  ds_read_b64_tr_b16 v[44:45], v11 offset:28672
  ds_read_b64_tr_b16 v[46:47], v11 offset:30720
  s_waitcnt lgkmcnt(12)
  v_mfma_f32_16x16x32_bf16 v[100:103], v[88:91], v[48:51], v[100:103]
  s_waitcnt lgkmcnt(10)
  v_mfma_f32_16x16x32_bf16 v[104:107], v[88:91], v[52:55], v[104:107]
  s_waitcnt lgkmcnt(8)
  v_mfma_f32_16x16x32_bf16 v[108:111], v[88:91], v[56:59], v[108:111]
  s_waitcnt vmcnt(0)
  s_waitcnt lgkmcnt(6)
  v_mfma_f32_16x16x32_bf16 v[96:99], v[92:95], v[32:35], v[96:99]
  s_waitcnt lgkmcnt(4)
  v_mfma_f32_16x16x32_bf16 v[100:103], v[92:95], v[36:39], v[100:103]
  s_waitcnt lgkmcnt(2)
  v_mfma_f32_16x16x32_bf16 v[104:107], v[92:95], v[40:43], v[104:107]
  s_waitcnt lgkmcnt(0)
  v_mfma_f32_16x16x32_bf16 v[108:111], v[92:95], v[44:47], v[108:111]
  s_lshl_b32 s24, s6, 11
  v_add_u32 v4, s24, v2
  s_xor_b32 s25, s6, 4
  s_lshl_b32 s25, s25, 11
  v_add_u32 v5, s25, v2
  v_lshrrev_b32 v6, 4, v1
  v_lshlrev_b32 v6, 2, v6
  s_and_b32 s24, s6, 3
  s_lshl_b32 s24, s24, 4
  v_add_u32 v6, s24, v6
  v_mul_u32_u24 v6, 272, v6
  v_and_b32 v7, 15, v1
  v_lshl_add_u32 v6, v7, 2, v6
  s_lshl_b32 s24, s31, 7
  s_add_u32 s24, s24, 146432
  v_add_u32 v6, s24, v6
  ds_read_b32 v112, v6 offset:0
  ds_read_b32 v113, v6 offset:272
  ds_read_b32 v114, v6 offset:544
  ds_read_b32 v115, v6 offset:816
  ds_read_b32 v116, v6 offset:64
  ds_read_b32 v117, v6 offset:336
  ds_read_b32 v118, v6 offset:608
  ds_read_b32 v119, v6 offset:880
  s_cmp_eq_u32 s31, 0
  s_cbranch_scc0 L_wo_52
  ds_write_b128 v4, v[104:107]
  ds_write_b128 v4, v[108:111] offset:1024
  s_branch L_wo_53
L_wo_52:
  ds_write_b128 v4, v[96:99]
  ds_write_b128 v4, v[100:103] offset:1024
  s_nop 1
  v_mov_b32 v96, v104
  v_mov_b32 v97, v105
  v_mov_b32 v98, v106
  v_mov_b32 v99, v107
  v_mov_b32 v100, v108
  v_mov_b32 v101, v109
  v_mov_b32 v102, v110
  v_mov_b32 v103, v111
L_wo_53:
  s_waitcnt lgkmcnt(2)
  v_add_f32 v96, v96, v112
  v_add_f32 v97, v97, v113
  v_add_f32 v98, v98, v114
  v_add_f32 v99, v99, v115
  v_add_f32 v100, v100, v116
  v_add_f32 v101, v101, v117
  v_add_f32 v102, v102, v118
  v_add_f32 v103, v103, v119
  s_waitcnt lgkmcnt(0)
  s_barrier
  ds_read_b128 v[104:107], v5
  ds_read_b128 v[108:111], v5 offset:1024
  s_lshl_b32 s24, s51, 1
  s_add_u32 s24, s24, s31
  s_lshl_b32 s25, s30, 4
  s_add_u32 s26, s25, s24
  s_lshl_b32 s27, s26, 7
  s_add_u32 s27, s27, s48
  s_add_u32 s27, s27, 8388608
  v_lshrrev_b32 v3, 4, v1
  v_lshlrev_b32 v3, 5, v3
  s_lshl_b32 s28, s7, 13
  s_add_u32 s28, s28, 32768
  s_lshl_b32 s29, s26, 2
  s_add_u32 s29, s29, s28
  s_waitcnt lgkmcnt(0)
  v_add_f32 v96, v96, v104
  v_add_f32 v97, v97, v105
  v_add_f32 v98, v98, v106
  v_add_f32 v99, v99, v107
  v_add_f32 v100, v100, v108
  v_add_f32 v101, v101, v109
  v_add_f32 v102, v102, v110
  v_add_f32 v103, v103, v111
  v_add_f32 v104, v96, v100
  v_mul_f32 v105, v96, v96
  v_fmac_f32 v105, v100, v100
  v_add_f32 v106, v97, v101
  v_mul_f32 v107, v97, v97
  v_fmac_f32 v107, v101, v101
  v_add_f32 v108, v98, v102
  v_mul_f32 v109, v98, v98
  v_fmac_f32 v109, v102, v102
  v_add_f32 v110, v99, v103
  v_mul_f32 v111, v99, v99
  v_fmac_f32 v111, v103, v103
  v_add_f32 v104, v104, v104 row_ror:8 row_mask:0xf bank_mask:0xf
  v_add_f32 v105, v105, v105 row_ror:8 row_mask:0xf bank_mask:0xf
  v_add_f32 v106, v106, v106 row_ror:8 row_mask:0xf bank_mask:0xf
  v_add_f32 v107, v107, v107 row_ror:8 row_mask:0xf bank_mask:0xf
  v_add_f32 v108, v108, v108 row_ror:8 row_mask:0xf bank_mask:0xf
  v_add_f32 v109, v109, v109 row_ror:8 row_mask:0xf bank_mask:0xf
  v_add_f32 v110, v110, v110 row_ror:8 row_mask:0xf bank_mask:0xf
  v_add_f32 v111, v111, v111 row_ror:8 row_mask:0xf bank_mask:0xf
  v_add_f32 v104, v104, v104 row_ror:4 row_mask:0xf bank_mask:0xf
  v_add_f32 v105, v105, v105 row_ror:4 row_mask:0xf bank_mask:0xf
  v_add_f32 v106, v106, v106 row_ror:4 row_mask:0xf bank_mask:0xf
  v_add_f32 v107, v107, v107 row_ror:4 row_mask:0xf bank_mask:0xf
  v_add_f32 v108, v108, v108 row_ror:4 row_mask:0xf bank_mask:0xf
  v_add_f32 v109, v109, v109 row_ror:4 row_mask:0xf bank_mask:0xf
  v_add_f32 v110, v110, v110 row_ror:4 row_mask:0xf bank_mask:0xf
  v_add_f32 v111, v111, v111 row_ror:4 row_mask:0xf bank_mask:0xf
  v_add_f32 v104, v104, v104 row_ror:2 row_mask:0xf bank_mask:0xf
  v_add_f32 v105, v105, v105 row_ror:2 row_mask:0xf bank_mask:0xf
  v_add_f32 v106, v106, v106 row_ror:2 row_mask:0xf bank_mask:0xf
  v_add_f32 v107, v107, v107 row_ror:2 row_mask:0xf bank_mask:0xf
  v_add_f32 v108, v108, v108 row_ror:2 row_mask:0xf bank_mask:0xf
  v_add_f32 v109, v109, v109 row_ror:2 row_mask:0xf bank_mask:0xf
  v_add_f32 v110, v110, v110 row_ror:2 row_mask:0xf bank_mask:0xf
  v_add_f32 v111, v111, v111 row_ror:2 row_mask:0xf bank_mask:0xf
  v_add_f32 v104, v104, v104 row_ror:1 row_mask:0xf bank_mask:0xf
  v_add_f32 v105, v105, v105 row_ror:1 row_mask:0xf bank_mask:0xf
  v_add_f32 v106, v106, v106 row_ror:1 row_mask:0xf bank_mask:0xf
  v_add_f32 v107, v107, v107 row_ror:1 row_mask:0xf bank_mask:0xf
  v_add_f32 v108, v108, v108 row_ror:1 row_mask:0xf bank_mask:0xf
  v_add_f32 v109, v109, v109 row_ror:1 row_mask:0xf bank_mask:0xf
  v_add_f32 v110, v110, v110 row_ror:1 row_mask:0xf bank_mask:0xf
  v_add_f32 v111, v111, v111 row_ror:1 row_mask:0xf bank_mask:0xf
  v_cmp_eq_u32 vcc, 0, v7
  s_nop 0
  s_and_saveexec_b64 s[36:37], vcc
  s_cmp_eq_u32 s54, 0
  s_cbranch_scc1 L_ls_54
  buffer_store_dwordx4 v[104:107], v3, s[8:11], s27 offen
  buffer_store_dwordx4 v[108:111], v3, s[8:11], s27 offen offset:16
  s_branch L_ls_55
L_ls_54:
  buffer_store_dwordx4 v[104:107], v3, s[8:11], s27 offen sc1
  buffer_store_dwordx4 v[108:111], v3, s[8:11], s27 offen offset:16 sc1
L_ls_55:
  s_mov_b64 exec, s[36:37]
  ds_write_b32 v6, v96 offset:0
  ds_write_b32 v6, v97 offset:272
  ds_write_b32 v6, v98 offset:544
  ds_write_b32 v6, v99 offset:816
  ds_write_b32 v6, v100 offset:64
  ds_write_b32 v6, v101 offset:336
  ds_write_b32 v6, v102 offset:608
  ds_write_b32 v6, v103 offset:880
  v_mov_b32 v4, 1
  s_lshl_b32 s34, s25, 2
  s_add_u32 s34, s34, s28
  v_min_u32 v5, 13, v1
  v_lshlrev_b32 v5, 2, v5
  v_add_u32 v5, s34, v5
  s_lshl_b32 s27, s25, 7
  s_add_u32 s27, s27, s48
  s_add_u32 s27, s27, 8388608
  v_lshl_add_u32 v8, v7, 7, v3
  v_mov_b32 v9, 0x7ff00000
  v_cmp_le_u32 vcc, 14, v7
  s_nop 1
  v_cndmask_b32 v8, v8, v9, vcc
  s_waitcnt vmcnt(0)
  s_mov_b64 exec, 1
  s_cmp_eq_u32 s54, 0
  s_cbranch_scc1 L_ls_56
  buffer_store_dword v4, off, s[8:11], s29
  s_branch L_ls_57
L_ls_56:
  buffer_store_dword v4, off, s[8:11], s29 sc1
L_ls_57:
  s_mov_b64 exec, -1
  s_mov_b32 s53, 0x40000
L_poll_58:
  buffer_load_dword v4, v5, s[8:11], 0 offen sc1
  s_waitcnt vmcnt(0)
  v_cmp_gt_u32 vcc, 1, v4
  s_nop 1
  s_cbranch_vccz L_polld_59
  s_sub_u32 s53, s53, 1
  s_cmp_lg_u32 s53, 0
  s_cbranch_scc1 L_poll_58
L_polld_59:
  buffer_load_dwordx4 v[104:107], v8, s[8:11], s27 offen sc1
  buffer_load_dwordx4 v[108:111], v8, s[8:11], s27 offen offset:16 sc1
  s_mov_b32 s24, 991054117
  s_mov_b32 s25, 925353388
  s_waitcnt vmcnt(0)
  v_add_f32 v104, v104, v104 row_ror:8 row_mask:0xf bank_mask:0xf
  v_add_f32 v105, v105, v105 row_ror:8 row_mask:0xf bank_mask:0xf
  v_add_f32 v106, v106, v106 row_ror:8 row_mask:0xf bank_mask:0xf
  v_add_f32 v107, v107, v107 row_ror:8 row_mask:0xf bank_mask:0xf
  v_add_f32 v108, v108, v108 row_ror:8 row_mask:0xf bank_mask:0xf
  v_add_f32 v109, v109, v109 row_ror:8 row_mask:0xf bank_mask:0xf
  v_add_f32 v110, v110, v110 row_ror:8 row_mask:0xf bank_mask:0xf
  v_add_f32 v111, v111, v111 row_ror:8 row_mask:0xf bank_mask:0xf
  v_add_f32 v104, v104, v104 row_ror:4 row_mask:0xf bank_mask:0xf
  v_add_f32 v105, v105, v105 row_ror:4 row_mask:0xf bank_mask:0xf
  v_add_f32 v106, v106, v106 row_ror:4 row_mask:0xf bank_mask:0xf
  v_add_f32 v107, v107, v107 row_ror:4 row_mask:0xf bank_mask:0xf
  v_add_f32 v108, v108, v108 row_ror:4 row_mask:0xf bank_mask:0xf
  v_add_f32 v109, v109, v109 row_ror:4 row_mask:0xf bank_mask:0xf
  v_add_f32 v110, v110, v110 row_ror:4 row_mask:0xf bank_mask:0xf
  v_add_f32 v111, v111, v111 row_ror:4 row_mask:0xf bank_mask:0xf
  v_add_f32 v104, v104, v104 row_ror:2 row_mask:0xf bank_mask:0xf
  v_add_f32 v105, v105, v105 row_ror:2 row_mask:0xf bank_mask:0xf
  v_add_f32 v106, v106, v106 row_ror:2 row_mask:0xf bank_mask:0xf
  v_add_f32 v107, v107, v107 row_ror:2 row_mask:0xf bank_mask:0xf
  v_add_f32 v108, v108, v108 row_ror:2 row_mask:0xf bank_mask:0xf
  v_add_f32 v109, v109, v109 row_ror:2 row_mask:0xf bank_mask:0xf
  v_add_f32 v110, v110, v110 row_ror:2 row_mask:0xf bank_mask:0xf
  v_add_f32 v111, v111, v111 row_ror:2 row_mask:0xf bank_mask:0xf
  v_add_f32 v104, v104, v104 row_ror:1 row_mask:0xf bank_mask:0xf
  v_add_f32 v105, v105, v105 row_ror:1 row_mask:0xf bank_mask:0xf
  v_add_f32 v106, v106, v106 row_ror:1 row_mask:0xf bank_mask:0xf
  v_add_f32 v107, v107, v107 row_ror:1 row_mask:0xf bank_mask:0xf
  v_add_f32 v108, v108, v108 row_ror:1 row_mask:0xf bank_mask:0xf
  v_add_f32 v109, v109, v109 row_ror:1 row_mask:0xf bank_mask:0xf
  v_add_f32 v110, v110, v110 row_ror:1 row_mask:0xf bank_mask:0xf
  v_add_f32 v111, v111, v111 row_ror:1 row_mask:0xf bank_mask:0xf
  v_mul_f32 v104, s24, v104
  v_mul_f32 v105, s24, v105
  v_mul_f32 v106, s24, v106
  v_mul_f32 v107, s24, v107
  v_mul_f32 v108, s24, v108
  v_mul_f32 v109, s24, v109
  v_mul_f32 v110, s24, v110
  v_mul_f32 v111, s24, v111
  v_fma_f32 v105, -v104, v104, v105
  v_max_f32 v105, 0, v105
  v_add_f32 v8, s25, v105
  v_fma_f32 v107, -v106, v106, v107
  v_max_f32 v107, 0, v107
  v_add_f32 v9, s25, v107
  v_fma_f32 v109, -v108, v108, v109
  v_max_f32 v109, 0, v109
  v_add_f32 v10, s25, v109
  v_fma_f32 v111, -v110, v110, v111
  v_max_f32 v111, 0, v111
  v_add_f32 v11, s25, v111
  v_rsq_f32 v8, v8
  v_rsq_f32 v9, v9
  v_rsq_f32 v10, v10
  v_rsq_f32 v11, v11
  v_mul_f32 v12, v8, v8
  v_mul_f32 v13, v9, v9
  v_mul_f32 v14, v10, v10
  v_mul_f32 v15, v11, v11
  v_fma_f32 v12, v12, v105, s25
  v_fma_f32 v13, v13, v107, s25
  v_fma_f32 v14, v14, v109, s25
  v_fma_f32 v15, v15, v111, s25
  v_rsq_f32 v12, v12
  v_rsq_f32 v13, v13
  v_rsq_f32 v14, v14
  v_rsq_f32 v15, v15
  v_sub_f32 v96, v96, v104
  v_sub_f32 v100, v100, v104
  v_sub_f32 v97, v97, v106
  v_sub_f32 v101, v101, v106
  v_sub_f32 v98, v98, v108
  v_sub_f32 v102, v102, v108
  v_sub_f32 v99, v99, v110
  v_sub_f32 v103, v103, v110
  v_mul_f32 v8, v8, v12
  v_mul_f32 v9, v9, v13
  v_mul_f32 v10, v10, v14
  v_mul_f32 v11, v11, v15
  v_mul_f32 v96, v96, v8
  v_mul_f32 v100, v100, v8
  v_mul_f32 v97, v97, v9
  v_mul_f32 v101, v101, v9
  v_mul_f32 v98, v98, v10
  v_mul_f32 v102, v102, v10
  v_mul_f32 v99, v99, v11
  v_mul_f32 v103, v103, v11
  v_cvt_pk_bf16_f32 v16, v96, v97
  v_cvt_pk_bf16_f32 v17, v98, v99
  v_cvt_pk_bf16_f32 v18, v100, v101
  v_cvt_pk_bf16_f32 v19, v102, v103
  s_lshl_b32 s24, s51, 1
  s_add_u32 s24, s24, s31
  s_lshl_b32 s24, s24, 7
  s_add_u32 s24, s24, s30
  s_lshl_b32 s24, s24, 10
  s_add_u32 s24, s24, s48
  s_add_u32 s24, s24, 9437184
  v_permlane16_swap_b32 v16, v18
  v_permlane16_swap_b32 v17, v19
  buffer_store_dwordx4 v[16:19], v2, s[8:11], s24 offen sc1
  s_waitcnt vmcnt(0) lgkmcnt(0)
  s_barrier
  s_cmp_lg_u32 s6, 0
  s_cbranch_scc1 L_sig_60
  s_add_u32 s24, s49, 3
  s_lshl_b32 s25, s2, 7
  v_mov_b32 v4, s24
  s_mov_b64 exec, 1
  buffer_store_dword v4, off, s[8:11], s25 sc1
  s_mov_b64 exec, -1
L_sig_60:
  buffer_load_dwordx4 v[176:179], v2, s[8:11], s56 offen offset:0 sc1
  buffer_load_dwordx4 v[180:183], v2, s[8:11], s56 offen offset:1024 sc1
  buffer_load_dwordx4 v[184:187], v2, s[8:11], s56 offen offset:2048 sc1
  buffer_load_dwordx4 v[188:191], v2, s[8:11], s56 offen offset:3072 sc1
  s_add_u32 s56, s56, 4096
  buffer_load_dwordx4 v[192:195], v2, s[8:11], s56 offen offset:0 sc1
  buffer_load_dwordx4 v[196:199], v2, s[8:11], s56 offen offset:1024 sc1
  buffer_load_dwordx4 v[200:203], v2, s[8:11], s56 offen offset:2048 sc1
  buffer_load_dwordx4 v[204:207], v2, s[8:11], s56 offen offset:3072 sc1
  s_add_u32 s56, s56, 4096
  buffer_load_dwordx4 v[208:211], v2, s[8:11], s56 offen offset:0 sc1
  buffer_load_dwordx4 v[212:215], v2, s[8:11], s56 offen offset:1024 sc1
  buffer_load_dwordx4 v[216:219], v2, s[8:11], s56 offen offset:2048 sc1
  buffer_load_dwordx4 v[220:223], v2, s[8:11], s56 offen offset:3072 sc1
  s_add_u32 s56, s56, 4096
  buffer_load_dwordx4 v[224:227], v2, s[8:11], s56 offen offset:0 sc1
  buffer_load_dwordx4 v[228:231], v2, s[8:11], s56 offen offset:1024 sc1
  buffer_load_dwordx4 v[232:235], v2, s[8:11], s56 offen offset:2048 sc1
  buffer_load_dwordx4 v[236:239], v2, s[8:11], s56 offen offset:3072 sc1
  s_add_u32 s56, s56, 4096
  buffer_load_dwordx4 v[240:243], v2, s[8:11], s56 offen offset:0 sc1
  buffer_load_dwordx4 v[244:247], v2, s[8:11], s56 offen offset:1024 sc1
  buffer_load_dwordx4 v[248:251], v2, s[8:11], s56 offen offset:2048 sc1
  buffer_load_dwordx4 v[252:255], v2, s[8:11], s56 offen offset:3072 sc1
  s_add_u32 s56, s56, 4096
  s_mul_i32 s24, s50, 112
  s_min_u32 s25, s6, 6
  s_lshl_b32 s25, s25, 4
  s_add_u32 s24, s24, s25
  s_load_dwordx4 s[40:43], s[74:75], s24
  s_add_u32 s32, s49, 3
  s_lshl_b32 s34, s51, 1
  s_mul_i32 s34, s34, 128
  s_mul_i32 s25, s6, 16
  s_add_u32 s34, s34, s25
  s_lshl_b32 s34, s34, 10
  s_add_u32 s34, s34, s48
  s_add_u32 s34, s34, 9437184
  s_add_u32 s35, s34, 131072
  s_cmp_lg_u32 s6, 0
  s_cbranch_scc1 L_wp_61
  v_and_b32 v3, 3, v1
  v_mul_u32_u24 v3, 7, v3
  v_add_u32 v3, s51, v3
  v_lshlrev_b32 v3, 3, v3
  v_bfe_u32 v5, v1, 2, 3
  v_add_u32 v3, v5, v3
  v_lshlrev_b32 v3, 7, v3
  s_mov_b32 s53, 0x40000
L_poll_62:
  buffer_load_dword v4, v3, s[8:11], 0 offen sc1
  s_waitcnt vmcnt(0)
  v_cmp_gt_u32 vcc, s32, v4
  s_nop 1
  s_cbranch_vccz L_polld_63
  s_sub_u32 s53, s53, 1
  s_cmp_lg_u32 s53, 0
  s_cbranch_scc1 L_poll_62
L_polld_63:
L_wp_61:
  s_barrier
  buffer_load_dwordx4 v[8:11], v2, s[8:11], s34 offen offset:0 sc1
  buffer_load_dwordx4 v[12:15], v2, s[8:11], s35 offen offset:0 sc1
  buffer_load_dwordx4 v[16:19], v2, s[8:11], s34 offen offset:1024 sc1
  buffer_load_dwordx4 v[20:23], v2, s[8:11], s35 offen offset:1024 sc1
  buffer_load_dwordx4 v[24:27], v2, s[8:11], s34 offen offset:2048 sc1
  buffer_load_dwordx4 v[28:31], v2, s[8:11], s35 offen offset:2048 sc1
  buffer_load_dwordx4 v[32:35], v2, s[8:11], s34 offen offset:3072 sc1
  buffer_load_dwordx4 v[36:39], v2, s[8:11], s35 offen offset:3072 sc1
  s_add_u32 s34, s34, 4096
  s_add_u32 s35, s35, 4096
  buffer_load_dwordx4 v[40:43], v2, s[8:11], s34 offen offset:0 sc1
  buffer_load_dwordx4 v[44:47], v2, s[8:11], s35 offen offset:0 sc1
  s_waitcnt vmcnt(8)
  v_mfma_f32_32x32x16_bf16 v[64:79], v[128:131], v[8:11], 0
  v_mfma_f32_32x32x16_bf16 v[96:111], v[132:135], v[8:11], 0
  v_mfma_f32_32x32x16_bf16 v[80:95], v[128:131], v[12:15], 0
  v_mfma_f32_32x32x16_bf16 v[112:127], v[132:135], v[12:15], 0
  buffer_load_dwordx4 v[8:11], v2, s[8:11], s34 offen offset:1024 sc1
  buffer_load_dwordx4 v[12:15], v2, s[8:11], s35 offen offset:1024 sc1
  s_waitcnt vmcnt(8)
  v_mfma_f32_32x32x16_bf16 v[64:79], v[136:139], v[16:19], v[64:79]
  v_mfma_f32_32x32x16_bf16 v[96:111], v[140:143], v[16:19], v[96:111]
  v_mfma_f32_32x32x16_bf16 v[80:95], v[136:139], v[20:23], v[80:95]
  v_mfma_f32_32x32x16_bf16 v[112:127], v[140:143], v[20:23], v[112:127]
  buffer_load_dwordx4 v[16:19], v2, s[8:11], s34 offen offset:2048 sc1
  buffer_load_dwordx4 v[20:23], v2, s[8:11], s35 offen offset:2048 sc1
  s_waitcnt vmcnt(8)
  v_mfma_f32_32x32x16_bf16 v[64:79], v[144:147], v[24:27], v[64:79]
  v_mfma_f32_32x32x16_bf16 v[96:111], v[148:151], v[24:27], v[96:111]
  v_mfma_f32_32x32x16_bf16 v[80:95], v[144:147], v[28:31], v[80:95]
  v_mfma_f32_32x32x16_bf16 v[112:127], v[148:151], v[28:31], v[112:127]
  buffer_load_dwordx4 v[24:27], v2, s[8:11], s34 offen offset:3072 sc1
  buffer_load_dwordx4 v[28:31], v2, s[8:11], s35 offen offset:3072 sc1
  s_add_u32 s34, s34, 4096
  s_add_u32 s35, s35, 4096
  s_waitcnt vmcnt(8)
  v_mfma_f32_32x32x16_bf16 v[64:79], v[152:155], v[32:35], v[64:79]
  v_mfma_f32_32x32x16_bf16 v[96:111], v[156:159], v[32:35], v[96:111]
  v_mfma_f32_32x32x16_bf16 v[80:95], v[152:155], v[36:39], v[80:95]
  v_mfma_f32_32x32x16_bf16 v[112:127], v[156:159], v[36:39], v[112:127]
  buffer_load_dwordx4 v[32:35], v2, s[8:11], s34 offen offset:0 sc1
  buffer_load_dwordx4 v[36:39], v2, s[8:11], s35 offen offset:0 sc1
  s_waitcnt vmcnt(8)
  v_mfma_f32_32x32x16_bf16 v[64:79], v[160:163], v[40:43], v[64:79]
  v_mfma_f32_32x32x16_bf16 v[96:111], v[164:167], v[40:43], v[96:111]
  v_mfma_f32_32x32x16_bf16 v[80:95], v[160:163], v[44:47], v[80:95]
  v_mfma_f32_32x32x16_bf16 v[112:127], v[164:167], v[44:47], v[112:127]
  buffer_load_dwordx4 v[40:43], v2, s[8:11], s34 offen offset:1024 sc1
  buffer_load_dwordx4 v[44:47], v2, s[8:11], s35 offen offset:1024 sc1
  s_waitcnt vmcnt(8)
  v_mfma_f32_32x32x16_bf16 v[64:79], v[168:171], v[8:11], v[64:79]
  v_mfma_f32_32x32x16_bf16 v[96:111], v[172:175], v[8:11], v[96:111]
  v_mfma_f32_32x32x16_bf16 v[80:95], v[168:171], v[12:15], v[80:95]
  v_mfma_f32_32x32x16_bf16 v[112:127], v[172:175], v[12:15], v[112:127]
  buffer_load_dwordx4 v[8:11], v2, s[8:11], s34 offen offset:2048 sc1
  buffer_load_dwordx4 v[12:15], v2, s[8:11], s35 offen offset:2048 sc1
  s_waitcnt vmcnt(8)
  v_mfma_f32_32x32x16_bf16 v[64:79], v[176:179], v[16:19], v[64:79]
  v_mfma_f32_32x32x16_bf16 v[96:111], v[180:183], v[16:19], v[96:111]
  v_mfma_f32_32x32x16_bf16 v[80:95], v[176:179], v[20:23], v[80:95]
  v_mfma_f32_32x32x16_bf16 v[112:127], v[180:183], v[20:23], v[112:127]
  buffer_load_dwordx4 v[16:19], v2, s[8:11], s34 offen offset:3072 sc1
  buffer_load_dwordx4 v[20:23], v2, s[8:11], s35 offen offset:3072 sc1
  s_add_u32 s34, s34, 4096
  s_add_u32 s35, s35, 4096
  s_waitcnt vmcnt(8)
  v_mfma_f32_32x32x16_bf16 v[64:79], v[184:187], v[24:27], v[64:79]
  v_mfma_f32_32x32x16_bf16 v[96:111], v[188:191], v[24:27], v[96:111]
  v_mfma_f32_32x32x16_bf16 v[80:95], v[184:187], v[28:31], v[80:95]
  v_mfma_f32_32x32x16_bf16 v[112:127], v[188:191], v[28:31], v[112:127]
  buffer_load_dwordx4 v[24:27], v2, s[8:11], s34 offen offset:0 sc1
  buffer_load_dwordx4 v[28:31], v2, s[8:11], s35 offen offset:0 sc1
  s_waitcnt vmcnt(8)
  v_mfma_f32_32x32x16_bf16 v[64:79], v[192:195], v[32:35], v[64:79]
  v_mfma_f32_32x32x16_bf16 v[96:111], v[196:199], v[32:35], v[96:111]
  v_mfma_f32_32x32x16_bf16 v[80:95], v[192:195], v[36:39], v[80:95]
  v_mfma_f32_32x32x16_bf16 v[112:127], v[196:199], v[36:39], v[112:127]
  buffer_load_dwordx4 v[32:35], v2, s[8:11], s34 offen offset:1024 sc1
  buffer_load_dwordx4 v[36:39], v2, s[8:11], s35 offen offset:1024 sc1
  s_waitcnt vmcnt(8)
  v_mfma_f32_32x32x16_bf16 v[64:79], v[200:203], v[40:43], v[64:79]
  v_mfma_f32_32x32x16_bf16 v[96:111], v[204:207], v[40:43], v[96:111]
  v_mfma_f32_32x32x16_bf16 v[80:95], v[200:203], v[44:47], v[80:95]
  v_mfma_f32_32x32x16_bf16 v[112:127], v[204:207], v[44:47], v[112:127]
  buffer_load_dwordx4 v[40:43], v2, s[8:11], s34 offen offset:2048 sc1
  buffer_load_dwordx4 v[44:47], v2, s[8:11], s35 offen offset:2048 sc1
  s_waitcnt vmcnt(8)
  v_mfma_f32_32x32x16_bf16 v[64:79], v[208:211], v[8:11], v[64:79]
  v_mfma_f32_32x32x16_bf16 v[96:111], v[212:215], v[8:11], v[96:111]
  v_mfma_f32_32x32x16_bf16 v[80:95], v[208:211], v[12:15], v[80:95]
  v_mfma_f32_32x32x16_bf16 v[112:127], v[212:215], v[12:15], v[112:127]
  buffer_load_dwordx4 v[8:11], v2, s[8:11], s34 offen offset:3072 sc1
  buffer_load_dwordx4 v[12:15], v2, s[8:11], s35 offen offset:3072 sc1
  s_add_u32 s34, s34, 4096
  s_add_u32 s35, s35, 4096
  s_waitcnt vmcnt(8)
  v_mfma_f32_32x32x16_bf16 v[64:79], v[216:219], v[16:19], v[64:79]
  v_mfma_f32_32x32x16_bf16 v[96:111], v[220:223], v[16:19], v[96:111]
  v_mfma_f32_32x32x16_bf16 v[80:95], v[216:219], v[20:23], v[80:95]
  v_mfma_f32_32x32x16_bf16 v[112:127], v[220:223], v[20:23], v[112:127]
  s_waitcnt vmcnt(6)
  v_mfma_f32_32x32x16_bf16 v[64:79], v[224:227], v[24:27], v[64:79]
  v_mfma_f32_32x32x16_bf16 v[96:111], v[228:231], v[24:27], v[96:111]
  v_mfma_f32_32x32x16_bf16 v[80:95], v[224:227], v[28:31], v[80:95]
  v_mfma_f32_32x32x16_bf16 v[112:127], v[228:231], v[28:31], v[112:127]
  s_waitcnt vmcnt(4)
  v_mfma_f32_32x32x16_bf16 v[64:79], v[232:235], v[32:35], v[64:79]
  v_mfma_f32_32x32x16_bf16 v[96:111], v[236:239], v[32:35], v[96:111]
  v_mfma_f32_32x32x16_bf16 v[80:95], v[232:235], v[36:39], v[80:95]
  v_mfma_f32_32x32x16_bf16 v[112:127], v[236:239], v[36:39], v[112:127]
  s_waitcnt vmcnt(2)
  v_mfma_f32_32x32x16_bf16 v[64:79], v[240:243], v[40:43], v[64:79]
  v_mfma_f32_32x32x16_bf16 v[96:111], v[244:247], v[40:43], v[96:111]
  v_mfma_f32_32x32x16_bf16 v[80:95], v[240:243], v[44:47], v[80:95]
  v_mfma_f32_32x32x16_bf16 v[112:127], v[244:247], v[44:47], v[112:127]
  s_waitcnt vmcnt(0)
  v_mfma_f32_32x32x16_bf16 v[64:79], v[248:251], v[8:11], v[64:79]
  v_mfma_f32_32x32x16_bf16 v[96:111], v[252:255], v[8:11], v[96:111]
  v_mfma_f32_32x32x16_bf16 v[80:95], v[248:251], v[12:15], v[80:95]
  v_mfma_f32_32x32x16_bf16 v[112:127], v[252:255], v[12:15], v[112:127]
  v_and_b32 v3, 31, v1
  v_mul_u32_u24 v3, 272, v3
  v_lshrrev_b32 v4, 5, v1
  v_lshl_add_u32 v3, v4, 4, v3
  s_mul_i32 s24, s6, 17408
  v_add_u32 v3, s24, v3
  s_nop 2
  ds_write_b128 v3, v[64:67] offset:0
  ds_write_b128 v3, v[68:71] offset:32
  ds_write_b128 v3, v[72:75] offset:64
  ds_write_b128 v3, v[76:79] offset:96
  ds_write_b128 v3, v[80:83] offset:8704
  ds_write_b128 v3, v[84:87] offset:8736
  ds_write_b128 v3, v[88:91] offset:8768
  ds_write_b128 v3, v[92:95] offset:8800
  ds_write_b128 v3, v[96:99] offset:128
  ds_write_b128 v3, v[100:103] offset:160
  ds_write_b128 v3, v[104:107] offset:192
  ds_write_b128 v3, v[108:111] offset:224
  ds_write_b128 v3, v[112:115] offset:8832
  ds_write_b128 v3, v[116:119] offset:8864
  ds_write_b128 v3, v[120:123] offset:8896
  ds_write_b128 v3, v[124:127] offset:8928
  v_mul_u32_u24 v3, 272, v1
  s_lshl_b32 s24, s6, 5
  v_add_u32 v3, s24, v3
  v_add_u32 v5, 69632, v3
  s_waitcnt lgkmcnt(0)
  s_barrier
  ds_read_b128 v[8:11], v3 offset:0
  ds_read_b128 v[12:15], v3 offset:16
  ds_read_b128 v[16:19], v3 offset:17408
  ds_read_b128 v[20:23], v3 offset:17424
  ds_read_b128 v[24:27], v3 offset:34816
  ds_read_b128 v[28:31], v3 offset:34832
  ds_read_b128 v[32:35], v3 offset:52224
  ds_read_b128 v[36:39], v3 offset:52240
  ds_read_b128 v[40:43], v5 offset:0
  ds_read_b128 v[44:47], v5 offset:16
  ds_read_b128 v[48:51], v5 offset:17408
  ds_read_b128 v[52:55], v5 offset:17424
  ds_read_b128 v[56:59], v5 offset:34816
  ds_read_b128 v[60:63], v5 offset:34832
  ds_read_b128 v[64:67], v5 offset:52224
  ds_read_b128 v[68:71], v5 offset:52240
  s_mul_i32 s56, s50, 229376
  s_mul_i32 s57, s6, 28672
  s_add_u32 s56, s56, s57
  s_add_u32 s56, s56, 12582912
  buffer_load_dwordx4 v[128:131], v2, s[8:11], s56 offen offset:0 sc1
  s_waitcnt lgkmcnt(12)
  v_add_f32 v8, v8, v16
  v_add_f32 v9, v9, v17
  v_add_f32 v10, v10, v18
  v_add_f32 v11, v11, v19
  v_add_f32 v12, v12, v20
  v_add_f32 v13, v13, v21
  v_add_f32 v14, v14, v22
  v_add_f32 v15, v15, v23
  buffer_load_dwordx4 v[132:135], v2, s[8:11], s56 offen offset:1024 sc1
  s_waitcnt lgkmcnt(10)
  v_add_f32 v8, v8, v24
  v_add_f32 v9, v9, v25
  v_add_f32 v10, v10, v26
  v_add_f32 v11, v11, v27
  v_add_f32 v12, v12, v28
  v_add_f32 v13, v13, v29
  v_add_f32 v14, v14, v30
  v_add_f32 v15, v15, v31
  buffer_load_dwordx4 v[136:139], v2, s[8:11], s56 offen offset:2048 sc1
  s_waitcnt lgkmcnt(8)
  v_add_f32 v8, v8, v32
  v_add_f32 v9, v9, v33
  v_add_f32 v10, v10, v34
  v_add_f32 v11, v11, v35
  v_add_f32 v12, v12, v36
  v_add_f32 v13, v13, v37
  v_add_f32 v14, v14, v38
  v_add_f32 v15, v15, v39
  buffer_load_dwordx4 v[140:143], v2, s[8:11], s56 offen offset:3072 sc1
  s_add_u32 s56, s56, 4096
  s_waitcnt lgkmcnt(6)
  v_add_f32 v8, v8, v40
  v_add_f32 v9, v9, v41
  v_add_f32 v10, v10, v42
  v_add_f32 v11, v11, v43
  v_add_f32 v12, v12, v44
  v_add_f32 v13, v13, v45
  v_add_f32 v14, v14, v46
  v_add_f32 v15, v15, v47
  buffer_load_dwordx4 v[144:147], v2, s[8:11], s56 offen offset:0 sc1
  s_waitcnt lgkmcnt(4)
  v_add_f32 v8, v8, v48
  v_add_f32 v9, v9, v49
  v_add_f32 v10, v10, v50
  v_add_f32 v11, v11, v51
  v_add_f32 v12, v12, v52
  v_add_f32 v13, v13, v53
  v_add_f32 v14, v14, v54
  v_add_f32 v15, v15, v55
  buffer_load_dwordx4 v[148:151], v2, s[8:11], s56 offen offset:1024 sc1
  s_waitcnt lgkmcnt(2)
  v_add_f32 v8, v8, v56
  v_add_f32 v9, v9, v57
  v_add_f32 v10, v10, v58
  v_add_f32 v11, v11, v59
  v_add_f32 v12, v12, v60
  v_add_f32 v13, v13, v61
  v_add_f32 v14, v14, v62
  v_add_f32 v15, v15, v63
  buffer_load_dwordx4 v[152:155], v2, s[8:11], s56 offen offset:2048 sc1
  s_waitcnt lgkmcnt(0)
  v_add_f32 v8, v8, v64
  v_add_f32 v9, v9, v65
  v_add_f32 v10, v10, v66
  v_add_f32 v11, v11, v67
  v_add_f32 v12, v12, v68
  v_add_f32 v13, v13, v69
  v_add_f32 v14, v14, v70
  v_add_f32 v15, v15, v71
  s_waitcnt lgkmcnt(0)
  buffer_load_dwordx4 v[156:159], v2, s[8:11], s56 offen offset:3072 sc1
  s_add_u32 s56, s56, 4096
  s_mov_b32 s24, 3222493025
  s_mov_b32 s25, 3184710632
  s_lshl_b32 s26, s40, 16
  v_add_f32 v8, s26, v8
  s_and_b32 s26, s40, 0xffff0000
  v_add_f32 v9, s26, v9
  s_lshl_b32 s26, s41, 16
  v_add_f32 v10, s26, v10
  s_and_b32 s26, s41, 0xffff0000
  v_add_f32 v11, s26, v11
  s_lshl_b32 s26, s42, 16
  v_add_f32 v12, s26, v12
  s_and_b32 s26, s42, 0xffff0000
  v_add_f32 v13, s26, v13
  s_lshl_b32 s26, s43, 16
  v_add_f32 v14, s26, v14
  s_and_b32 s26, s43, 0xffff0000
  v_add_f32 v15, s26, v15
  v_mul_f32 v16, v8, v8
  v_mov_b32 v24, s24
  v_mul_f32 v17, v9, v9
  v_mov_b32 v25, s24
  v_mul_f32 v18, v10, v10
  v_mov_b32 v26, s24
  v_mul_f32 v19, v11, v11
  v_mov_b32 v27, s24
  v_mul_f32 v20, v12, v12
  v_mov_b32 v28, s24
  v_mul_f32 v21, v13, v13
  v_mov_b32 v29, s24
  v_mul_f32 v22, v14, v14
  v_mov_b32 v30, s24
  v_mul_f32 v23, v15, v15
  v_mov_b32 v31, s24
  v_fmac_f32 v24, s25, v16
  v_fmac_f32 v25, s25, v17
  v_fmac_f32 v26, s25, v18
  v_fmac_f32 v27, s25, v19
  v_fmac_f32 v28, s25, v20
  v_fmac_f32 v29, s25, v21
  v_fmac_f32 v30, s25, v22
  v_fmac_f32 v31, s25, v23
  v_mul_f32 v24, v24, v8
  v_mul_f32 v25, v25, v9
  v_mul_f32 v26, v26, v10
  v_mul_f32 v27, v27, v11
  v_mul_f32 v28, v28, v12
  v_mul_f32 v29, v29, v13
  v_mul_f32 v30, v30, v14
  v_mul_f32 v31, v31, v15
  v_exp_f32 v24, v24
  v_exp_f32 v25, v25
  v_exp_f32 v26, v26
  v_exp_f32 v27, v27
  v_exp_f32 v28, v28
  v_exp_f32 v29, v29
  v_exp_f32 v30, v30
  v_exp_f32 v31, v31
  v_add_f32 v24, 1.0, v24
  v_add_f32 v25, 1.0, v25
  v_add_f32 v26, 1.0, v26
  v_add_f32 v27, 1.0, v27
  v_add_f32 v28, 1.0, v28
  v_add_f32 v29, 1.0, v29
  v_add_f32 v30, 1.0, v30
  v_add_f32 v31, 1.0, v31
  v_rcp_f32 v24, v24
  v_rcp_f32 v25, v25
  v_rcp_f32 v26, v26
  v_rcp_f32 v27, v27
  v_rcp_f32 v28, v28
  v_rcp_f32 v29, v29
  v_rcp_f32 v30, v30
  v_rcp_f32 v31, v31
  v_mul_f32 v8, v8, v24
  v_mul_f32 v9, v9, v25
  v_mul_f32 v10, v10, v26
  v_mul_f32 v11, v11, v27
  v_mul_f32 v12, v12, v28
  v_mul_f32 v13, v13, v29
  v_mul_f32 v14, v14, v30
  v_mul_f32 v15, v15, v31
  v_cvt_pk_bf16_f32 v16, v8, v9
  v_cvt_pk_bf16_f32 v17, v10, v11
  v_cvt_pk_bf16_f32 v18, v12, v13
  v_cvt_pk_bf16_f32 v19, v14, v15
  s_mul_i32 s24, s50, 7
  s_add_u32 s24, s24, s6
  s_lshr_b32 s25, s24, 1
  s_and_b32 s24, s24, 1
  s_lshl_b32 s26, s51, 1
  s_mul_i32 s26, s26, 112
  s_add_u32 s26, s26, s25
  s_lshl_b32 s26, s26, 10
  s_lshl_b32 s24, s24, 9
  s_add_u32 s26, s26, s24
  s_add_u32 s26, s26, s48
  s_add_u32 s26, s26, 11534336
  v_and_b32 v3, 31, v1
  v_lshlrev_b32 v3, 4, v3
  v_lshrrev_b32 v4, 5, v1
  v_mul_u32_u24 v4, 114688, v4
  v_add_u32 v3, v3, v4
  s_cmp_eq_u32 s6, 7
  s_cbranch_scc1 L_b1_64
  buffer_store_dwordx4 v[16:19], v3, s[8:11], s26 offen sc1
L_b1_64:
  s_waitcnt vmcnt(0) lgkmcnt(0)
  s_barrier
  s_cmp_lg_u32 s6, 0
  s_cbranch_scc1 L_sig_65
  s_add_u32 s24, s49, 4
  s_lshl_b32 s25, s2, 7
  v_mov_b32 v4, s24
  s_mov_b64 exec, 1
  buffer_store_dword v4, off, s[8:11], s25 sc1
  s_mov_b64 exec, -1
L_sig_65:
  buffer_load_dwordx4 v[160:163], v2, s[8:11], s56 offen offset:0 sc1
  buffer_load_dwordx4 v[164:167], v2, s[8:11], s56 offen offset:1024 sc1
  buffer_load_dwordx4 v[168:171], v2, s[8:11], s56 offen offset:2048 sc1
  buffer_load_dwordx4 v[172:175], v2, s[8:11], s56 offen offset:3072 sc1
  s_add_u32 s56, s56, 4096
  buffer_load_dwordx4 v[176:179], v2, s[8:11], s56 offen offset:0 sc1
  buffer_load_dwordx4 v[180:183], v2, s[8:11], s56 offen offset:1024 sc1
  buffer_load_dwordx4 v[184:187], v2, s[8:11], s56 offen offset:2048 sc1
  buffer_load_dwordx4 v[188:191], v2, s[8:11], s56 offen offset:3072 sc1
  s_add_u32 s56, s56, 4096
  buffer_load_dwordx4 v[192:195], v2, s[8:11], s56 offen offset:0 sc1
  buffer_load_dwordx4 v[196:199], v2, s[8:11], s56 offen offset:1024 sc1
  buffer_load_dwordx4 v[200:203], v2, s[8:11], s56 offen offset:2048 sc1
  buffer_load_dwordx4 v[204:207], v2, s[8:11], s56 offen offset:3072 sc1
  s_add_u32 s56, s56, 4096
  buffer_load_dwordx4 v[208:211], v2, s[8:11], s56 offen offset:0 sc1
  buffer_load_dwordx4 v[212:215], v2, s[8:11], s56 offen offset:1024 sc1
  buffer_load_dwordx4 v[216:219], v2, s[8:11], s56 offen offset:2048 sc1
  buffer_load_dwordx4 v[220:223], v2, s[8:11], s56 offen offset:3072 sc1
  s_add_u32 s56, s56, 4096
  buffer_load_dwordx4 v[224:227], v2, s[8:11], s56 offen offset:0 sc1
  buffer_load_dwordx4 v[228:231], v2, s[8:11], s56 offen offset:1024 sc1
  buffer_load_dwordx4 v[232:235], v2, s[8:11], s56 offen offset:2048 sc1
  buffer_load_dwordx4 v[236:239], v2, s[8:11], s56 offen offset:3072 sc1
  s_add_u32 s56, s56, 4096
  s_mov_b32 s16, s78
  s_mov_b32 s17, s79
  s_mov_b32 s18, 4096
  s_mov_b32 s19, 0x20000
  s_lshl_b32 s24, s50, 7
  v_lshlrev_b32 v5, 1, v1
  buffer_load_ushort v240, v5, s[16:19], s24 offen
  s_add_u32 s32, s49, 4
  s_lshl_b32 s34, s51, 1
  s_mul_i32 s34, s34, 112
  s_mul_i32 s25, s6, 14
  s_add_u32 s34, s34, s25
  s_lshl_b32 s34, s34, 10
  s_add_u32 s34, s34, s48
  s_add_u32 s34, s34, 11534336
  s_add_u32 s35, s34, 114688
  s_cmp_lg_u32 s6, 0
  s_cbranch_scc1 L_wp_66
  v_and_b32 v3, 3, v1
  v_mul_u32_u24 v3, 7, v3
  v_add_u32 v3, s51, v3
  v_lshlrev_b32 v3, 3, v3
  v_bfe_u32 v5, v1, 2, 3
  v_add_u32 v3, v5, v3
  v_lshlrev_b32 v3, 7, v3
  v_and_b32 v5, 3, v1
  v_add_u32 v5, 28, v5
  v_lshlrev_b32 v5, 3, v5
  v_bfe_u32 v6, v1, 2, 2
  v_add_u32 v5, v5, v6
  v_lshlrev_b32 v5, 7, v5
  v_cmp_le_u32 vcc, 32, v1
  s_cmp_eq_u32 s7, 0
  s_cselect_b64 s[36:37], vcc, 0
  v_cndmask_b32 v3, v3, v5, s[36:37]
  s_mov_b32 s53, 0x40000
L_poll_67:
  buffer_load_dword v4, v3, s[8:11], 0 offen sc1
  s_waitcnt vmcnt(0)
  v_cmp_gt_u32 vcc, s32, v4
  s_nop 1
  s_cbranch_vccz L_polld_68
  s_sub_u32 s53, s53, 1
  s_cmp_lg_u32 s53, 0
  s_cbranch_scc1 L_poll_67
L_polld_68:
L_wp_66:
  s_barrier
  buffer_load_dwordx4 v[8:11], v2, s[8:11], s34 offen offset:0 sc1
  buffer_load_dwordx4 v[12:15], v2, s[8:11], s35 offen offset:0 sc1
  buffer_load_dwordx4 v[16:19], v2, s[8:11], s34 offen offset:1024 sc1
  buffer_load_dwordx4 v[20:23], v2, s[8:11], s35 offen offset:1024 sc1
  buffer_load_dwordx4 v[24:27], v2, s[8:11], s34 offen offset:2048 sc1
  buffer_load_dwordx4 v[28:31], v2, s[8:11], s35 offen offset:2048 sc1
  buffer_load_dwordx4 v[32:35], v2, s[8:11], s34 offen offset:3072 sc1
  buffer_load_dwordx4 v[36:39], v2, s[8:11], s35 offen offset:3072 sc1
  s_add_u32 s34, s34, 4096
  s_add_u32 s35, s35, 4096
  buffer_load_dwordx4 v[40:43], v2, s[8:11], s34 offen offset:0 sc1
  buffer_load_dwordx4 v[44:47], v2, s[8:11], s35 offen offset:0 sc1
  s_waitcnt vmcnt(8)
  v_mfma_f32_32x32x16_bf16 v[64:79], v[8:11], v[128:131], 0
  v_mfma_f32_32x32x16_bf16 v[80:95], v[8:11], v[132:135], 0
  v_mfma_f32_32x32x16_bf16 v[96:111], v[12:15], v[128:131], 0
  v_mfma_f32_32x32x16_bf16 v[112:127], v[12:15], v[132:135], 0
  buffer_load_dwordx4 v[8:11], v2, s[8:11], s34 offen offset:1024 sc1
  buffer_load_dwordx4 v[12:15], v2, s[8:11], s35 offen offset:1024 sc1
  s_waitcnt vmcnt(8)
  v_mfma_f32_32x32x16_bf16 v[64:79], v[16:19], v[136:139], v[64:79]
  v_mfma_f32_32x32x16_bf16 v[80:95], v[16:19], v[140:143], v[80:95]
  v_mfma_f32_32x32x16_bf16 v[96:111], v[20:23], v[136:139], v[96:111]
  v_mfma_f32_32x32x16_bf16 v[112:127], v[20:23], v[140:143], v[112:127]
  buffer_load_dwordx4 v[16:19], v2, s[8:11], s34 offen offset:2048 sc1
  buffer_load_dwordx4 v[20:23], v2, s[8:11], s35 offen offset:2048 sc1
  s_waitcnt vmcnt(8)
  v_mfma_f32_32x32x16_bf16 v[64:79], v[24:27], v[144:147], v[64:79]
  v_mfma_f32_32x32x16_bf16 v[80:95], v[24:27], v[148:151], v[80:95]
  v_mfma_f32_32x32x16_bf16 v[96:111], v[28:31], v[144:147], v[96:111]
  v_mfma_f32_32x32x16_bf16 v[112:127], v[28:31], v[148:151], v[112:127]
  buffer_load_dwordx4 v[24:27], v2, s[8:11], s34 offen offset:3072 sc1
  buffer_load_dwordx4 v[28:31], v2, s[8:11], s35 offen offset:3072 sc1
  s_add_u32 s34, s34, 4096
  s_add_u32 s35, s35, 4096
  s_waitcnt vmcnt(8)
  v_mfma_f32_32x32x16_bf16 v[64:79], v[32:35], v[152:155], v[64:79]
  v_mfma_f32_32x32x16_bf16 v[80:95], v[32:35], v[156:159], v[80:95]
  v_mfma_f32_32x32x16_bf16 v[96:111], v[36:39], v[152:155], v[96:111]
  v_mfma_f32_32x32x16_bf16 v[112:127], v[36:39], v[156:159], v[112:127]
  buffer_load_dwordx4 v[32:35], v2, s[8:11], s34 offen offset:0 sc1
  buffer_load_dwordx4 v[36:39], v2, s[8:11], s35 offen offset:0 sc1
  s_waitcnt vmcnt(8)
  v_mfma_f32_32x32x16_bf16 v[64:79], v[40:43], v[160:163], v[64:79]
  v_mfma_f32_32x32x16_bf16 v[80:95], v[40:43], v[164:167], v[80:95]
  v_mfma_f32_32x32x16_bf16 v[96:111], v[44:47], v[160:163], v[96:111]
  v_mfma_f32_32x32x16_bf16 v[112:127], v[44:47], v[164:167], v[112:127]
  buffer_load_dwordx4 v[40:43], v2, s[8:11], s34 offen offset:1024 sc1
  buffer_load_dwordx4 v[44:47], v2, s[8:11], s35 offen offset:1024 sc1
  s_waitcnt vmcnt(8)
  v_mfma_f32_32x32x16_bf16 v[64:79], v[8:11], v[168:171], v[64:79]
  v_mfma_f32_32x32x16_bf16 v[80:95], v[8:11], v[172:175], v[80:95]
  v_mfma_f32_32x32x16_bf16 v[96:111], v[12:15], v[168:171], v[96:111]
  v_mfma_f32_32x32x16_bf16 v[112:127], v[12:15], v[172:175], v[112:127]
  buffer_load_dwordx4 v[8:11], v2, s[8:11], s34 offen offset:2048 sc1
  buffer_load_dwordx4 v[12:15], v2, s[8:11], s35 offen offset:2048 sc1
  s_waitcnt vmcnt(8)
  v_mfma_f32_32x32x16_bf16 v[64:79], v[16:19], v[176:179], v[64:79]
  v_mfma_f32_32x32x16_bf16 v[80:95], v[16:19], v[180:183], v[80:95]
  v_mfma_f32_32x32x16_bf16 v[96:111], v[20:23], v[176:179], v[96:111]
  v_mfma_f32_32x32x16_bf16 v[112:127], v[20:23], v[180:183], v[112:127]
  buffer_load_dwordx4 v[16:19], v2, s[8:11], s34 offen offset:3072 sc1
  buffer_load_dwordx4 v[20:23], v2, s[8:11], s35 offen offset:3072 sc1
  s_add_u32 s34, s34, 4096
  s_add_u32 s35, s35, 4096
  s_waitcnt vmcnt(8)
  v_mfma_f32_32x32x16_bf16 v[64:79], v[24:27], v[184:187], v[64:79]
  v_mfma_f32_32x32x16_bf16 v[80:95], v[24:27], v[188:191], v[80:95]
  v_mfma_f32_32x32x16_bf16 v[96:111], v[28:31], v[184:187], v[96:111]
  v_mfma_f32_32x32x16_bf16 v[112:127], v[28:31], v[188:191], v[112:127]
  buffer_load_dwordx4 v[24:27], v2, s[8:11], s34 offen offset:0 sc1
  buffer_load_dwordx4 v[28:31], v2, s[8:11], s35 offen offset:0 sc1
  s_waitcnt vmcnt(8)
  v_mfma_f32_32x32x16_bf16 v[64:79], v[32:35], v[192:195], v[64:79]
  v_mfma_f32_32x32x16_bf16 v[80:95], v[32:35], v[196:199], v[80:95]
  v_mfma_f32_32x32x16_bf16 v[96:111], v[36:39], v[192:195], v[96:111]
  v_mfma_f32_32x32x16_bf16 v[112:127], v[36:39], v[196:199], v[112:127]
  buffer_load_dwordx4 v[32:35], v2, s[8:11], s34 offen offset:1024 sc1
  buffer_load_dwordx4 v[36:39], v2, s[8:11], s35 offen offset:1024 sc1
  s_waitcnt vmcnt(8)
  v_mfma_f32_32x32x16_bf16 v[64:79], v[40:43], v[200:203], v[64:79]
  v_mfma_f32_32x32x16_bf16 v[80:95], v[40:43], v[204:207], v[80:95]
  v_mfma_f32_32x32x16_bf16 v[96:111], v[44:47], v[200:203], v[96:111]
  v_mfma_f32_32x32x16_bf16 v[112:127], v[44:47], v[204:207], v[112:127]
  s_waitcnt vmcnt(6)
  v_mfma_f32_32x32x16_bf16 v[64:79], v[8:11], v[208:211], v[64:79]
  v_mfma_f32_32x32x16_bf16 v[80:95], v[8:11], v[212:215], v[80:95]
  v_mfma_f32_32x32x16_bf16 v[96:111], v[12:15], v[208:211], v[96:111]
  v_mfma_f32_32x32x16_bf16 v[112:127], v[12:15], v[212:215], v[112:127]
  s_waitcnt vmcnt(4)
  v_mfma_f32_32x32x16_bf16 v[64:79], v[16:19], v[216:219], v[64:79]
  v_mfma_f32_32x32x16_bf16 v[80:95], v[16:19], v[220:223], v[80:95]
  v_mfma_f32_32x32x16_bf16 v[96:111], v[20:23], v[216:219], v[96:111]
  v_mfma_f32_32x32x16_bf16 v[112:127], v[20:23], v[220:223], v[112:127]
  s_waitcnt vmcnt(2)
  v_mfma_f32_32x32x16_bf16 v[64:79], v[24:27], v[224:227], v[64:79]
  v_mfma_f32_32x32x16_bf16 v[80:95], v[24:27], v[228:231], v[80:95]
  v_mfma_f32_32x32x16_bf16 v[96:111], v[28:31], v[224:227], v[96:111]
  v_mfma_f32_32x32x16_bf16 v[112:127], v[28:31], v[228:231], v[112:127]
  s_waitcnt vmcnt(0)
  v_mfma_f32_32x32x16_bf16 v[64:79], v[32:35], v[232:235], v[64:79]
  v_mfma_f32_32x32x16_bf16 v[80:95], v[32:35], v[236:239], v[80:95]
  v_mfma_f32_32x32x16_bf16 v[96:111], v[36:39], v[232:235], v[96:111]
  v_mfma_f32_32x32x16_bf16 v[112:127], v[36:39], v[236:239], v[112:127]
  s_cmp_lg_u32 s7, 0
  s_nop 0
  s_cbranch_scc1 L_wq_69
  s_and_b32 s24, s5, 15
  s_mul_i32 s24, s24, 92160
  s_add_u32 s24, s24, 1048576
  s_lshl_b32 s25, s6, 10
  s_add_u32 s24, s24, s25
  s_add_u32 s27, s24, 0
  buffer_load_dwordx4 v[128:131], v2, s[8:11], s27 offen sc1
  s_add_u32 s27, s24, 8192
  buffer_load_dwordx4 v[132:135], v2, s[8:11], s27 offen sc1
  s_add_u32 s27, s24, 16384
  buffer_load_dwordx4 v[136:139], v2, s[8:11], s27 offen sc1
  s_add_u32 s27, s24, 24576
  buffer_load_dwordx4 v[140:143], v2, s[8:11], s27 offen sc1
  s_add_u32 s27, s24, 32768
  buffer_load_dwordx4 v[144:147], v2, s[8:11], s27 offen sc1
  s_add_u32 s27, s24, 40960
  buffer_load_dwordx4 v[148:151], v2, s[8:11], s27 offen sc1
  s_add_u32 s27, s24, 49152
  buffer_load_dwordx4 v[152:155], v2, s[8:11], s27 offen sc1
  s_add_u32 s27, s24, 57344
  buffer_load_dwordx4 v[156:159], v2, s[8:11], s27 offen sc1
  s_add_u32 s27, s24, 65536
  buffer_load_dwordx4 v[160:163], v2, s[8:11], s27 offen sc1
  s_add_u32 s27, s24, 73728
  buffer_load_dwordx4 v[164:167], v2, s[8:11], s27 offen sc1
  s_add_u32 s27, s24, 81920
  buffer_load_dwordx4 v[168:171], v2, s[8:11], s27 offen sc1
L_wq_69:
  v_and_b32 v3, 31, v1
  v_mul_u32_u24 v3, 272, v3
  v_lshrrev_b32 v4, 5, v1
  v_lshl_add_u32 v3, v4, 4, v3
  s_mul_i32 s24, s6, 17408
  v_add_u32 v3, s24, v3
  ds_write_b128 v3, v[64:67] offset:0
  ds_write_b128 v3, v[68:71] offset:32
  ds_write_b128 v3, v[72:75] offset:64
  ds_write_b128 v3, v[76:79] offset:96
  ds_write_b128 v3, v[80:83] offset:8704
  ds_write_b128 v3, v[84:87] offset:8736
  ds_write_b128 v3, v[88:91] offset:8768
  ds_write_b128 v3, v[92:95] offset:8800
  ds_write_b128 v3, v[96:99] offset:128
  ds_write_b128 v3, v[100:103] offset:160
  ds_write_b128 v3, v[104:107] offset:192
  ds_write_b128 v3, v[108:111] offset:224
  ds_write_b128 v3, v[112:115] offset:8832
  ds_write_b128 v3, v[116:119] offset:8864
  ds_write_b128 v3, v[120:123] offset:8896
  ds_write_b128 v3, v[124:127] offset:8928
  v_mul_u32_u24 v3, 272, v1
  s_lshl_b32 s24, s6, 5
  v_add_u32 v3, s24, v3
  v_add_u32 v5, 69632, v3
  s_waitcnt lgkmcnt(0)
  s_barrier
  ds_read_b128 v[8:11], v3 offset:0
  ds_read_b128 v[12:15], v3 offset:16
  ds_read_b128 v[16:19], v3 offset:17408
  ds_read_b128 v[20:23], v3 offset:17424
  ds_read_b128 v[24:27], v3 offset:34816
  ds_read_b128 v[28:31], v3 offset:34832
  ds_read_b128 v[32:35], v3 offset:52224
  ds_read_b128 v[36:39], v3 offset:52240
  ds_read_b128 v[40:43], v5 offset:0
  ds_read_b128 v[44:47], v5 offset:16
  ds_read_b128 v[48:51], v5 offset:17408
  ds_read_b128 v[52:55], v5 offset:17424
  ds_read_b128 v[56:59], v5 offset:34816
  ds_read_b128 v[60:63], v5 offset:34832
  ds_read_b128 v[64:67], v5 offset:52224
  ds_read_b128 v[68:71], v5 offset:52240
  v_add_u32 v6, 146432, v3
  ds_read_b128 v[72:75], v6
  ds_read_b128 v[76:79], v6 offset:16
  s_waitcnt lgkmcnt(14)
  v_add_f32 v8, v8, v16
  v_add_f32 v9, v9, v17
  v_add_f32 v10, v10, v18
  v_add_f32 v11, v11, v19
  v_add_f32 v12, v12, v20
  v_add_f32 v13, v13, v21
  v_add_f32 v14, v14, v22
  v_add_f32 v15, v15, v23
  s_waitcnt lgkmcnt(12)
  v_add_f32 v8, v8, v24
  v_add_f32 v9, v9, v25
  v_add_f32 v10, v10, v26
  v_add_f32 v11, v11, v27
  v_add_f32 v12, v12, v28
  v_add_f32 v13, v13, v29
  v_add_f32 v14, v14, v30
  v_add_f32 v15, v15, v31
  s_waitcnt lgkmcnt(10)
  v_add_f32 v8, v8, v32
  v_add_f32 v9, v9, v33
  v_add_f32 v10, v10, v34
  v_add_f32 v11, v11, v35
  v_add_f32 v12, v12, v36
  v_add_f32 v13, v13, v37
  v_add_f32 v14, v14, v38
  v_add_f32 v15, v15, v39
  s_waitcnt lgkmcnt(8)
  v_add_f32 v8, v8, v40
  v_add_f32 v9, v9, v41
  v_add_f32 v10, v10, v42
  v_add_f32 v11, v11, v43
  v_add_f32 v12, v12, v44
  v_add_f32 v13, v13, v45
  v_add_f32 v14, v14, v46
  v_add_f32 v15, v15, v47
  s_waitcnt lgkmcnt(6)
  v_add_f32 v8, v8, v48
  v_add_f32 v9, v9, v49
  v_add_f32 v10, v10, v50
  v_add_f32 v11, v11, v51
  v_add_f32 v12, v12, v52
  v_add_f32 v13, v13, v53
  v_add_f32 v14, v14, v54
  v_add_f32 v15, v15, v55
  s_waitcnt lgkmcnt(4)
  v_add_f32 v8, v8, v56
  v_add_f32 v9, v9, v57
  v_add_f32 v10, v10, v58
  v_add_f32 v11, v11, v59
  v_add_f32 v12, v12, v60
  v_add_f32 v13, v13, v61
  v_add_f32 v14, v14, v62
  v_add_f32 v15, v15, v63
  s_waitcnt lgkmcnt(2)
  v_add_f32 v8, v8, v64
  v_add_f32 v9, v9, v65
  v_add_f32 v10, v10, v66
  v_add_f32 v11, v11, v67
  v_add_f32 v12, v12, v68
  v_add_f32 v13, v13, v69
  v_add_f32 v14, v14, v70
  v_add_f32 v15, v15, v71
  s_waitcnt lgkmcnt(0)
  v_lshlrev_b32 v4, 16, v240
  v_add_f32 v8, v8, v4
  v_add_f32 v8, v8, v72
  v_add_f32 v9, v9, v4
  v_add_f32 v9, v9, v73
  v_add_f32 v10, v10, v4
  v_add_f32 v10, v10, v74
  v_add_f32 v11, v11, v4
  v_add_f32 v11, v11, v75
  v_add_f32 v12, v12, v4
  v_add_f32 v12, v12, v76
  v_add_f32 v13, v13, v4
  v_add_f32 v13, v13, v77
  v_add_f32 v14, v14, v4
  v_add_f32 v14, v14, v78
  v_add_f32 v15, v15, v4
  v_add_f32 v15, v15, v79
  ds_write_b128 v6, v[8:11]
  ds_write_b128 v6, v[12:15] offset:16
  v_cvt_pk_bf16_f32 v16, v8, v9
  v_cvt_pk_bf16_f32 v17, v10, v11
  v_cvt_pk_bf16_f32 v18, v12, v13
  v_cvt_pk_bf16_f32 v19, v14, v15
  s_cmp_eq_u32 s7, 0
  s_cbranch_scc0 L_b2_70
  v_and_b32 v3, 15, v1
  v_lshrrev_b32 v4, 2, v3
  v_lshlrev_b32 v7, 1, v4
  v_mov_b32 v5, 0x78
  v_lshrrev_b32 v5, v7, v5
  v_and_b32 v5, 3, v5
  s_and_b32 s24, s6, 3
  v_xor_b32 v5, s24, v5
  v_lshl_add_u32 v5, v3, 2, v5
  v_lshlrev_b32 v5, 4, v5
  v_lshrrev_b32 v4, 4, v1
  v_mul_u32_u24 v4, 14336, v4
  v_add_u32 v5, v5, v4
  s_lshl_b32 s24, s50, 2
  s_mul_i32 s24, s24, 14
  s_lshl_b32 s25, s51, 1
  s_add_u32 s24, s24, s25
  s_lshr_b32 s25, s6, 2
  s_add_u32 s24, s24, s25
  s_lshl_b32 s24, s24, 10
  s_add_u32 s24, s24, 47185920
  s_cmp_eq_u32 s54, 0
  s_cbranch_scc1 L_ls_72
  buffer_store_dwordx4 v[16:19], v5, s[8:11], s24 offen
  s_branch L_ls_73
L_ls_72:
  buffer_store_dwordx4 v[16:19], v5, s[8:11], s24 offen sc1
L_ls_73:
  s_branch L_b2_71
L_b2_70:
  s_mov_b32 s16, s80
  s_mov_b32 s17, s81
  s_mov_b32 s18, 1835008
  s_mov_b32 s19, 0x20000
  s_mul_i32 s24, s50, 57344
  s_lshl_b32 s25, s51, 7
  s_add_u32 s24, s24, s25
  s_lshl_b32 s25, s6, 4
  s_add_u32 s24, s24, s25
  v_mul_u32_u24 v5, 896, v1
  buffer_store_dwordx4 v[16:19], v5, s[16:19], s24 offen
L_b2_71:
  s_waitcnt vmcnt(0) lgkmcnt(0)
  s_barrier
  s_cmp_lg_u32 s6, 0
  s_cbranch_scc1 L_sig_74
  s_add_u32 s24, s49, 5
  s_lshl_b32 s25, s4, 7
  s_lshl_b32 s26, s5, 2
  s_add_u32 s25, s25, s26
  s_add_u32 s25, s25, 49152
  v_mov_b32 v4, s24
  s_mov_b64 exec, 1
  s_cmp_eq_u32 s54, 0
  s_cbranch_scc1 L_ls_75
  buffer_store_dword v4, off, s[8:11], s25
  s_branch L_ls_76
L_ls_75:
  buffer_store_dword v4, off, s[8:11], s25 sc1
L_ls_76:
  s_mov_b64 exec, -1
L_sig_74:
  s_branch L_skip
L_idle:
  s_cmp_lg_u32 s7, 0
  s_cbranch_scc1 L_skip
  s_lshl_b32 s61, s4, 2
  s_add_u32 s61, s61, s5
  s_sub_u32 s61, s61, 28
  s_cmp_ge_u32 s61, 16
  s_cbranch_scc1 L_ns_77
  s_mov_b32 s12, s66
  s_mov_b32 s13, s67
  s_mov_b32 s14, 1204224
  s_mov_b32 s15, 0x20000
  v_add_u32 v3, 0, v1
  v_mul_u32_u24 v4, 171, v3
  v_lshrrev_b32 v4, 11, v4
  v_mul_u32_u24 v5, 12, v4
  v_sub_u32 v5, v3, v5
  v_lshrrev_b32 v6, 2, v5
  v_and_b32 v5, 3, v5
  v_bfe_u32 v7, v4, 3, 1
  v_lshlrev_b32 v7, 1, v7
  v_xor_b32 v5, v5, v7
  v_mul_u32_u24 v4, 2688, v4
  v_mul_u32_u24 v6, 896, v6
  v_lshlrev_b32 v5, 4, v5
  v_add3_u32 v8, v4, v5, v6
  v_add_u32 v3, 64, v1
  v_mul_u32_u24 v4, 171, v3
  v_lshrrev_b32 v4, 11, v4
  v_mul_u32_u24 v5, 12, v4
  v_sub_u32 v5, v3, v5
  v_lshrrev_b32 v6, 2, v5
  v_and_b32 v5, 3, v5
  v_bfe_u32 v7, v4, 3, 1
  v_lshlrev_b32 v7, 1, v7
  v_xor_b32 v5, v5, v7
  v_mul_u32_u24 v4, 2688, v4
  v_mul_u32_u24 v6, 896, v6
  v_lshlrev_b32 v5, 4, v5
  v_add3_u32 v9, v4, v5, v6
  v_add_u32 v3, 128, v1
  v_mul_u32_u24 v4, 171, v3
  v_lshrrev_b32 v4, 11, v4
  v_mul_u32_u24 v5, 12, v4
  v_sub_u32 v5, v3, v5
  v_lshrrev_b32 v6, 2, v5
  v_and_b32 v5, 3, v5
  v_bfe_u32 v7, v4, 3, 1
  v_lshlrev_b32 v7, 1, v7
  v_xor_b32 v5, v5, v7
  v_mul_u32_u24 v4, 2688, v4
  v_mul_u32_u24 v6, 896, v6
  v_lshlrev_b32 v5, 4, v5
  v_add3_u32 v10, v4, v5, v6
  s_mul_i32 s24, s61, 56
  s_mul_i32 s25, s6, 43008
  s_add_u32 s24, s24, s25
  s_mul_i32 s26, s6, 3072
  s_add_u32 m0, s26, 0
  s_add_u32 s27, s24, 0
  buffer_load_dwordx4 v8, s[12:15], s27 offen lds
  s_add_u32 m0, s26, 1024
  s_add_u32 s27, s24, 0
  buffer_load_dwordx4 v9, s[12:15], s27 offen lds
  s_add_u32 m0, s26, 2048
  s_add_u32 s27, s24, 0
  buffer_load_dwordx4 v10, s[12:15], s27 offen lds
  s_add_u32 m0, s26, 24576
  s_add_u32 s27, s24, 344064
  buffer_load_dwordx4 v8, s[12:15], s27 offen lds
  s_add_u32 m0, s26, 25600
  s_add_u32 s27, s24, 344064
  buffer_load_dwordx4 v9, s[12:15], s27 offen lds
  s_add_u32 m0, s26, 26624
  s_add_u32 s27, s24, 344064
  buffer_load_dwordx4 v10, s[12:15], s27 offen lds
  s_add_u32 m0, s26, 49152
  s_add_u32 s27, s24, 688128
  buffer_load_dwordx4 v8, s[12:15], s27 offen lds
  s_add_u32 m0, s26, 50176
  s_add_u32 s27, s24, 688128
  buffer_load_dwordx4 v9, s[12:15], s27 offen lds
  s_add_u32 m0, s26, 51200
  s_add_u32 s27, s24, 688128
  buffer_load_dwordx4 v10, s[12:15], s27 offen lds
  s_cmp_ge_u32 s6, 4
  s_cbranch_scc1 L_qw_78
  s_add_u32 m0, s26, 73728
  s_add_u32 s27, s24, 1032192
  buffer_load_dwordx4 v8, s[12:15], s27 offen lds
  s_add_u32 m0, s26, 74752
  s_add_u32 s27, s24, 1032192
  buffer_load_dwordx4 v9, s[12:15], s27 offen lds
  s_add_u32 m0, s26, 75776
  s_add_u32 s27, s24, 1032192
  buffer_load_dwordx4 v10, s[12:15], s27 offen lds
L_qw_78:
  s_waitcnt vmcnt(0)
  s_barrier
  v_lshrrev_b32 v3, 4, v1
  v_bfe_u32 v4, v1, 2, 2
  v_lshl_add_u32 v4, v3, 3, v4
  v_mul_u32_u24 v4, 192, v4
  v_and_b32 v5, 1, v1
  v_lshl_add_u32 v4, v5, 3, v4
  v_bfe_u32 v5, v1, 1, 1
  v_and_b32 v6, 1, v3
  v_lshlrev_b32 v6, 1, v6
  v_xor_b32 v5, v5, v6
  v_xor_b32 v6, 2, v5
  v_lshl_add_u32 v24, v5, 4, v4
  v_lshl_add_u32 v25, v6, 4, v4
  s_and_b32 s24, s6, 1
  s_cmp_eq_u32 s24, 0
  s_cselect_b64 vcc, -1, 0
  s_lshl_b32 s25, s24, 6
  v_cndmask_b32 v26, v25, v24, vcc
  v_add_u32 v26, 128, v26
  v_add_u32 v24, s25, v24
  v_add_u32 v25, s25, v25
  ds_read_b64_tr_b16 v[88:89], v24 offset:0
  ds_read_b64_tr_b16 v[90:91], v24 offset:768
  ds_read_b64_tr_b16 v[92:93], v25 offset:0
  ds_read_b64_tr_b16 v[94:95], v25 offset:768
  ds_read_b64_tr_b16 v[96:97], v26 offset:0
  ds_read_b64_tr_b16 v[98:99], v26 offset:768
  ds_read_b64_tr_b16 v[100:101], v24 offset:6144
  ds_read_b64_tr_b16 v[102:103], v24 offset:6912
  ds_read_b64_tr_b16 v[104:105], v25 offset:6144
  ds_read_b64_tr_b16 v[106:107], v25 offset:6912
  ds_read_b64_tr_b16 v[108:109], v26 offset:6144
  ds_read_b64_tr_b16 v[110:111], v26 offset:6912
  s_waitcnt lgkmcnt(6)
  ds_read_b64_tr_b16 v[112:113], v24 offset:12288
  ds_read_b64_tr_b16 v[114:115], v24 offset:13056
  ds_read_b64_tr_b16 v[116:117], v25 offset:12288
  ds_read_b64_tr_b16 v[118:119], v25 offset:13056
  ds_read_b64_tr_b16 v[120:121], v26 offset:12288
  ds_read_b64_tr_b16 v[122:123], v26 offset:13056
  ds_read_b64_tr_b16 v[124:125], v24 offset:18432
  ds_read_b64_tr_b16 v[126:127], v24 offset:19200
  ds_read_b64_tr_b16 v[128:129], v25 offset:18432
  ds_read_b64_tr_b16 v[130:131], v25 offset:19200
  ds_read_b64_tr_b16 v[132:133], v26 offset:18432
  ds_read_b64_tr_b16 v[134:135], v26 offset:19200
  s_waitcnt lgkmcnt(6)
  ds_read_b64_tr_b16 v[136:137], v24 offset:24576
  ds_read_b64_tr_b16 v[138:139], v24 offset:25344
  ds_read_b64_tr_b16 v[140:141], v25 offset:24576
  ds_read_b64_tr_b16 v[142:143], v25 offset:25344
  ds_read_b64_tr_b16 v[144:145], v26 offset:24576
  ds_read_b64_tr_b16 v[146:147], v26 offset:25344
  ds_read_b64_tr_b16 v[148:149], v24 offset:30720
  ds_read_b64_tr_b16 v[150:151], v24 offset:31488
  ds_read_b64_tr_b16 v[152:153], v25 offset:30720
  ds_read_b64_tr_b16 v[154:155], v25 offset:31488
  ds_read_b64_tr_b16 v[156:157], v26 offset:30720
  ds_read_b64_tr_b16 v[158:159], v26 offset:31488
  s_waitcnt lgkmcnt(6)
  ds_read_b64_tr_b16 v[160:161], v24 offset:36864
  ds_read_b64_tr_b16 v[162:163], v24 offset:37632
  ds_read_b64_tr_b16 v[164:165], v25 offset:36864
  ds_read_b64_tr_b16 v[166:167], v25 offset:37632
  ds_read_b64_tr_b16 v[168:169], v26 offset:36864
  ds_read_b64_tr_b16 v[170:171], v26 offset:37632
  ds_read_b64_tr_b16 v[172:173], v24 offset:43008
  ds_read_b64_tr_b16 v[174:175], v24 offset:43776
  ds_read_b64_tr_b16 v[176:177], v25 offset:43008
  ds_read_b64_tr_b16 v[178:179], v25 offset:43776
  ds_read_b64_tr_b16 v[180:181], v26 offset:43008
  ds_read_b64_tr_b16 v[182:183], v26 offset:43776
  s_waitcnt lgkmcnt(6)
  v_add_u32 v24, 49152, v24
  v_add_u32 v25, 49152, v25
  v_add_u32 v26, 49152, v26
  ds_read_b64_tr_b16 v[184:185], v24 offset:0
  ds_read_b64_tr_b16 v[186:187], v24 offset:768
  ds_read_b64_tr_b16 v[188:189], v25 offset:0
  ds_read_b64_tr_b16 v[190:191], v25 offset:768
  ds_read_b64_tr_b16 v[192:193], v26 offset:0
  ds_read_b64_tr_b16 v[194:195], v26 offset:768
  ds_read_b64_tr_b16 v[196:197], v24 offset:6144
  ds_read_b64_tr_b16 v[198:199], v24 offset:6912
  ds_read_b64_tr_b16 v[200:201], v25 offset:6144
  ds_read_b64_tr_b16 v[202:203], v25 offset:6912
  ds_read_b64_tr_b16 v[204:205], v26 offset:6144
  ds_read_b64_tr_b16 v[206:207], v26 offset:6912
  s_waitcnt lgkmcnt(6)
  ds_read_b64_tr_b16 v[208:209], v24 offset:12288
  ds_read_b64_tr_b16 v[210:211], v24 offset:13056
  ds_read_b64_tr_b16 v[212:213], v25 offset:12288
  ds_read_b64_tr_b16 v[214:215], v25 offset:13056
  ds_read_b64_tr_b16 v[216:217], v26 offset:12288
  ds_read_b64_tr_b16 v[218:219], v26 offset:13056
  ds_read_b64_tr_b16 v[220:221], v24 offset:18432
  ds_read_b64_tr_b16 v[222:223], v24 offset:19200
  ds_read_b64_tr_b16 v[224:225], v25 offset:18432
  ds_read_b64_tr_b16 v[226:227], v25 offset:19200
  ds_read_b64_tr_b16 v[228:229], v26 offset:18432
  ds_read_b64_tr_b16 v[230:231], v26 offset:19200
  s_waitcnt lgkmcnt(6)
  ds_read_b64_tr_b16 v[232:233], v24 offset:24576
  ds_read_b64_tr_b16 v[234:235], v24 offset:25344
  ds_read_b64_tr_b16 v[236:237], v25 offset:24576
  ds_read_b64_tr_b16 v[238:239], v25 offset:25344
  ds_read_b64_tr_b16 v[240:241], v26 offset:24576
  ds_read_b64_tr_b16 v[242:243], v26 offset:25344
  ds_read_b64_tr_b16 v[244:245], v24 offset:30720
  ds_read_b64_tr_b16 v[246:247], v24 offset:31488
  ds_read_b64_tr_b16 v[248:249], v25 offset:30720
  ds_read_b64_tr_b16 v[250:251], v25 offset:31488
  ds_read_b64_tr_b16 v[252:253], v26 offset:30720
  ds_read_b64_tr_b16 v[254:255], v26 offset:31488
  s_waitcnt lgkmcnt(6)
  s_waitcnt lgkmcnt(0)
  s_barrier
  v_and_b32 v3, 15, v1
  v_cmp_eq_u32 vcc, 12, v3
  v_mov_b32 v4, 0x3f803f80
  s_nop 0
  v_cndmask_b32 v92, v92, v4, vcc
  v_cndmask_b32 v93, v93, v4, vcc
  v_cndmask_b32 v94, v94, v4, vcc
  v_cndmask_b32 v95, v95, v4, vcc
  v_cndmask_b32 v104, v104, v4, vcc
  v_cndmask_b32 v105, v105, v4, vcc
  v_cndmask_b32 v106, v106, v4, vcc
  v_cndmask_b32 v107, v107, v4, vcc
  v_cndmask_b32 v116, v116, v4, vcc
  v_cndmask_b32 v117, v117, v4, vcc
  v_cndmask_b32 v118, v118, v4, vcc
  v_cndmask_b32 v119, v119, v4, vcc
  v_cndmask_b32 v128, v128, v4, vcc
  v_cndmask_b32 v129, v129, v4, vcc
  v_cndmask_b32 v130, v130, v4, vcc
  v_cndmask_b32 v131, v131, v4, vcc
  v_cndmask_b32 v140, v140, v4, vcc
  v_cndmask_b32 v141, v141, v4, vcc
  v_cndmask_b32 v142, v142, v4, vcc
  v_cndmask_b32 v143, v143, v4, vcc
  v_cndmask_b32 v152, v152, v4, vcc
  v_cndmask_b32 v153, v153, v4, vcc
  v_cndmask_b32 v154, v154, v4, vcc
  v_cndmask_b32 v155, v155, v4, vcc
  v_cndmask_b32 v164, v164, v4, vcc
  v_cndmask_b32 v165, v165, v4, vcc
  v_cndmask_b32 v166, v166, v4, vcc
  v_cndmask_b32 v167, v167, v4, vcc
  v_cndmask_b32 v176, v176, v4, vcc
  v_cndmask_b32 v177, v177, v4, vcc
  v_cndmask_b32 v178, v178, v4, vcc
  v_cndmask_b32 v179, v179, v4, vcc
  v_cndmask_b32 v188, v188, v4, vcc
  v_cndmask_b32 v189, v189, v4, vcc
  v_cndmask_b32 v190, v190, v4, vcc
  v_cndmask_b32 v191, v191, v4, vcc
  v_cndmask_b32 v200, v200, v4, vcc
  v_cndmask_b32 v201, v201, v4, vcc
  v_cndmask_b32 v202, v202, v4, vcc
  v_cndmask_b32 v203, v203, v4, vcc
  v_cndmask_b32 v212, v212, v4, vcc
  v_cndmask_b32 v213, v213, v4, vcc
  v_cndmask_b32 v214, v214, v4, vcc
  v_cndmask_b32 v215, v215, v4, vcc
  v_cndmask_b32 v224, v224, v4, vcc
  v_cndmask_b32 v225, v225, v4, vcc
  v_cndmask_b32 v226, v226, v4, vcc
  v_cndmask_b32 v227, v227, v4, vcc
  v_cndmask_b32 v236, v236, v4, vcc
  v_cndmask_b32 v237, v237, v4, vcc
  v_cndmask_b32 v238, v238, v4, vcc
  v_cndmask_b32 v239, v239, v4, vcc
  v_cndmask_b32 v248, v248, v4, vcc
  v_cndmask_b32 v249, v249, v4, vcc
  v_cndmask_b32 v250, v250, v4, vcc
  v_cndmask_b32 v251, v251, v4, vcc
  s_nop 4
  v_mov_b32 v84, 0x3f803f80
  v_mov_b32 v85, 0x3f803f80
  v_mov_b32 v86, 0x3f803f80
  v_mov_b32 v87, 0x3f803f80
  s_nop 1
  v_mfma_f32_16x16x32_bf16 v[52:55], v[88:91], v[84:87], 0
  v_mfma_f32_16x16x32_bf16 v[56:59], v[92:95], v[84:87], 0
  v_mfma_f32_16x16x32_bf16 v[60:63], v[84:87], v[96:99], 0
  v_mfma_f32_16x16x32_bf16 v[52:55], v[100:103], v[84:87], v[52:55]
  v_mfma_f32_16x16x32_bf16 v[56:59], v[104:107], v[84:87], v[56:59]
  v_mfma_f32_16x16x32_bf16 v[60:63], v[84:87], v[108:111], v[60:63]
  v_mfma_f32_16x16x32_bf16 v[52:55], v[112:115], v[84:87], v[52:55]
  v_mfma_f32_16x16x32_bf16 v[56:59], v[116:119], v[84:87], v[56:59]
  v_mfma_f32_16x16x32_bf16 v[60:63], v[84:87], v[120:123], v[60:63]
  v_mfma_f32_16x16x32_bf16 v[52:55], v[124:127], v[84:87], v[52:55]
  v_mfma_f32_16x16x32_bf16 v[56:59], v[128:131], v[84:87], v[56:59]
  v_mfma_f32_16x16x32_bf16 v[60:63], v[84:87], v[132:135], v[60:63]
  v_mfma_f32_16x16x32_bf16 v[52:55], v[136:139], v[84:87], v[52:55]
  v_mfma_f32_16x16x32_bf16 v[56:59], v[140:143], v[84:87], v[56:59]
  v_mfma_f32_16x16x32_bf16 v[60:63], v[84:87], v[144:147], v[60:63]
  v_mfma_f32_16x16x32_bf16 v[52:55], v[148:151], v[84:87], v[52:55]
  v_mfma_f32_16x16x32_bf16 v[56:59], v[152:155], v[84:87], v[56:59]
  v_mfma_f32_16x16x32_bf16 v[60:63], v[84:87], v[156:159], v[60:63]
  v_mfma_f32_16x16x32_bf16 v[52:55], v[160:163], v[84:87], v[52:55]
  v_mfma_f32_16x16x32_bf16 v[56:59], v[164:167], v[84:87], v[56:59]
  v_mfma_f32_16x16x32_bf16 v[60:63], v[84:87], v[168:171], v[60:63]
  v_mfma_f32_16x16x32_bf16 v[52:55], v[172:175], v[84:87], v[52:55]
  v_mfma_f32_16x16x32_bf16 v[56:59], v[176:179], v[84:87], v[56:59]
  v_mfma_f32_16x16x32_bf16 v[60:63], v[84:87], v[180:183], v[60:63]
  v_mfma_f32_16x16x32_bf16 v[52:55], v[184:187], v[84:87], v[52:55]
  v_mfma_f32_16x16x32_bf16 v[56:59], v[188:191], v[84:87], v[56:59]
  v_mfma_f32_16x16x32_bf16 v[60:63], v[84:87], v[192:195], v[60:63]
  v_mfma_f32_16x16x32_bf16 v[52:55], v[196:199], v[84:87], v[52:55]
  v_mfma_f32_16x16x32_bf16 v[56:59], v[200:203], v[84:87], v[56:59]
  v_mfma_f32_16x16x32_bf16 v[60:63], v[84:87], v[204:207], v[60:63]
  v_mfma_f32_16x16x32_bf16 v[52:55], v[208:211], v[84:87], v[52:55]
  v_mfma_f32_16x16x32_bf16 v[56:59], v[212:215], v[84:87], v[56:59]
  v_mfma_f32_16x16x32_bf16 v[60:63], v[84:87], v[216:219], v[60:63]
  v_mfma_f32_16x16x32_bf16 v[52:55], v[220:223], v[84:87], v[52:55]
  v_mfma_f32_16x16x32_bf16 v[56:59], v[224:227], v[84:87], v[56:59]
  v_mfma_f32_16x16x32_bf16 v[60:63], v[84:87], v[228:231], v[60:63]
  v_mfma_f32_16x16x32_bf16 v[52:55], v[232:235], v[84:87], v[52:55]
  v_mfma_f32_16x16x32_bf16 v[56:59], v[236:239], v[84:87], v[56:59]
  v_mfma_f32_16x16x32_bf16 v[60:63], v[84:87], v[240:243], v[60:63]
  v_mfma_f32_16x16x32_bf16 v[52:55], v[244:247], v[84:87], v[52:55]
  v_mfma_f32_16x16x32_bf16 v[56:59], v[248:251], v[84:87], v[56:59]
  v_mfma_f32_16x16x32_bf16 v[60:63], v[84:87], v[252:255], v[60:63]
  s_nop 15
  s_cmp_ge_u32 s6, 2
  s_cbranch_scc1 L_qs_79
  s_lshl_b32 s24, s61, 1
  s_add_u32 s24, s24, s6
  s_mul_i32 s24, s24, 46080
  s_add_u32 s24, s24, 1048576
  buffer_store_dwordx4 v[88:91], v2, s[8:11], s24 offen offset:0 sc1
  buffer_store_dwordx4 v[92:95], v2, s[8:11], s24 offen offset:1024 sc1
  buffer_store_dwordx4 v[96:99], v2, s[8:11], s24 offen offset:2048 sc1
  buffer_store_dwordx4 v[100:103], v2, s[8:11], s24 offen offset:3072 sc1
  s_add_u32 s24, s24, 4096
  buffer_store_dwordx4 v[104:107], v2, s[8:11], s24 offen offset:0 sc1
  buffer_store_dwordx4 v[108:111], v2, s[8:11], s24 offen offset:1024 sc1
  buffer_store_dwordx4 v[112:115], v2, s[8:11], s24 offen offset:2048 sc1
  buffer_store_dwordx4 v[116:119], v2, s[8:11], s24 offen offset:3072 sc1
  s_add_u32 s24, s24, 4096
  buffer_store_dwordx4 v[120:123], v2, s[8:11], s24 offen offset:0 sc1
  buffer_store_dwordx4 v[124:127], v2, s[8:11], s24 offen offset:1024 sc1
  buffer_store_dwordx4 v[128:131], v2, s[8:11], s24 offen offset:2048 sc1
  buffer_store_dwordx4 v[132:135], v2, s[8:11], s24 offen offset:3072 sc1
  s_add_u32 s24, s24, 4096
  buffer_store_dwordx4 v[136:139], v2, s[8:11], s24 offen offset:0 sc1
  buffer_store_dwordx4 v[140:143], v2, s[8:11], s24 offen offset:1024 sc1
  buffer_store_dwordx4 v[144:147], v2, s[8:11], s24 offen offset:2048 sc1
  buffer_store_dwordx4 v[148:151], v2, s[8:11], s24 offen offset:3072 sc1
  s_add_u32 s24, s24, 4096
  buffer_store_dwordx4 v[152:155], v2, s[8:11], s24 offen offset:0 sc1
  buffer_store_dwordx4 v[156:159], v2, s[8:11], s24 offen offset:1024 sc1
  buffer_store_dwordx4 v[160:163], v2, s[8:11], s24 offen offset:2048 sc1
  buffer_store_dwordx4 v[164:167], v2, s[8:11], s24 offen offset:3072 sc1
  s_add_u32 s24, s24, 4096
  buffer_store_dwordx4 v[168:171], v2, s[8:11], s24 offen offset:0 sc1
  buffer_store_dwordx4 v[172:175], v2, s[8:11], s24 offen offset:1024 sc1
  buffer_store_dwordx4 v[176:179], v2, s[8:11], s24 offen offset:2048 sc1
  buffer_store_dwordx4 v[180:183], v2, s[8:11], s24 offen offset:3072 sc1
  s_add_u32 s24, s24, 4096
  buffer_store_dwordx4 v[184:187], v2, s[8:11], s24 offen offset:0 sc1
  buffer_store_dwordx4 v[188:191], v2, s[8:11], s24 offen offset:1024 sc1
  buffer_store_dwordx4 v[192:195], v2, s[8:11], s24 offen offset:2048 sc1
  buffer_store_dwordx4 v[196:199], v2, s[8:11], s24 offen offset:3072 sc1
  s_add_u32 s24, s24, 4096
  buffer_store_dwordx4 v[200:203], v2, s[8:11], s24 offen offset:0 sc1
  buffer_store_dwordx4 v[204:207], v2, s[8:11], s24 offen offset:1024 sc1
  buffer_store_dwordx4 v[208:211], v2, s[8:11], s24 offen offset:2048 sc1
  buffer_store_dwordx4 v[212:215], v2, s[8:11], s24 offen offset:3072 sc1
  s_add_u32 s24, s24, 4096
  buffer_store_dwordx4 v[216:219], v2, s[8:11], s24 offen offset:0 sc1
  buffer_store_dwordx4 v[220:223], v2, s[8:11], s24 offen offset:1024 sc1
  buffer_store_dwordx4 v[224:227], v2, s[8:11], s24 offen offset:2048 sc1
  buffer_store_dwordx4 v[228:231], v2, s[8:11], s24 offen offset:3072 sc1
  s_add_u32 s24, s24, 4096
  buffer_store_dwordx4 v[232:235], v2, s[8:11], s24 offen offset:0 sc1
  buffer_store_dwordx4 v[236:239], v2, s[8:11], s24 offen offset:1024 sc1
  buffer_store_dwordx4 v[240:243], v2, s[8:11], s24 offen offset:2048 sc1
  buffer_store_dwordx4 v[244:247], v2, s[8:11], s24 offen offset:3072 sc1
  s_add_u32 s24, s24, 4096
  buffer_store_dwordx4 v[248:251], v2, s[8:11], s24 offen offset:0 sc1
  buffer_store_dwordx4 v[252:255], v2, s[8:11], s24 offen offset:1024 sc1
  buffer_store_dwordx4 v[52:55], v2, s[8:11], s24 offen offset:2048 sc1
  buffer_store_dwordx4 v[56:59], v2, s[8:11], s24 offen offset:3072 sc1
  s_add_u32 s24, s24, 4096
  buffer_store_dwordx4 v[60:63], v2, s[8:11], s24 offen offset:0 sc1
L_qs_79:
  s_waitcnt vmcnt(0) lgkmcnt(0)
  s_barrier
  s_cmp_lg_u32 s6, 0
  s_cbranch_scc1 L_sig_80
  s_add_u32 s24, s49, 4
  s_lshl_b32 s25, s2, 7
  v_mov_b32 v4, s24
  s_mov_b64 exec, 1
  buffer_store_dword v4, off, s[8:11], s25 sc1
  s_mov_b64 exec, -1
L_sig_80:
L_ns_77:
  s_and_b32 s61, s5, 15
  s_add_u32 s32, s49, 5
  s_cmp_lg_u32 s6, 0
  s_cbranch_scc1 L_wp_81
  v_min_u32 v3, 13, v1
  s_lshr_b32 s24, s5, 4
  s_mul_i32 s24, s24, 14
  v_add_u32 v3, s24, v3
  v_lshlrev_b32 v3, 2, v3
  s_lshl_b32 s24, s4, 7
  s_add_u32 s24, s24, 49152
  v_add_u32 v3, s24, v3
  s_mov_b32 s53, 0x40000
L_poll_82:
  buffer_load_dword v4, v3, s[8:11], 0 offen sc1
  s_waitcnt vmcnt(0)
  v_cmp_gt_u32 vcc, s32, v4
  s_nop 1
  s_cbranch_vccz L_polld_83
  s_sub_u32 s53, s53, 1
  s_cmp_lg_u32 s53, 0
  s_cbranch_scc1 L_poll_82
L_polld_83:
L_wp_81:
  s_barrier
L_skip:
  s_add_u32 s7, s7, 1
  s_add_u32 s49, s49, 5
  s_add_u32 s48, s48, 16777216
  s_cmp_lt_u32 s7, 2
  s_cbranch_scc1 L_layer
L_end:
  s_endpgm
.section .rodata,"a"
.p2align 6
.amdhsa_kernel interleave_layers__sliding_block__mixer_token_mlp__prompt_kernel
  .amdhsa_next_free_vgpr 256
  .amdhsa_next_free_sgpr 102
  .amdhsa_accum_offset 256
  .amdhsa_group_segment_fixed_size 0
  .amdhsa_kernarg_size 88
  .amdhsa_user_sgpr_count 2
  .amdhsa_user_sgpr_kernarg_segment_ptr 1
  .amdhsa_system_sgpr_workgroup_id_x 1
.end_amdhsa_kernel
```
